```python
import torch

def _softmax(x, axis=-1):
    return torch.softmax(x, dim=axis)

def _gelu(x):
    return torch.nn.functional.gelu(x, approximate='tanh')

def _silu(x):
    return torch.nn.functional.silu(x)

def _sigmoid(x):
    return torch.sigmoid(x)

def _layernorm(x, axis=-1, eps=1e-05):
    m = x.mean(dim=axis, keepdim=True)
    v = x.var(dim=axis, keepdim=True, unbiased=False)
    return (x - m) / torch.sqrt(v + eps)

def _scatter_add(tgt, idx, src, axis=0):
    return tgt.clone().index_add_(axis, idx, src)

def _segment_sum(src, seg, n):
    out = torch.zeros((n,) + src.shape[1:], dtype=src.dtype)
    return out.index_add_(0, seg, src)

def _pad(x, pw):
    flat = tuple((v for pair in reversed(pw) for v in pair))
    return torch.nn.functional.pad(x, flat)
kernel_name = 'gather_scatter__tensor_product_equiv_equiformer__graph'

def setup_inputs():

    _w = lambda a: (lambda t: t.to(torch.bfloat16) if t.is_floating_point() else t)(torch.as_tensor(a))
    N, deg, C, De = (12500, 64, 64, max(0, 1))
    E = N * deg
    src = (lambda lo, hi, *s: torch.randint(lo, hi, s))(0, N, E).to(torch.int64)
    dst = (lambda lo, hi, *s: torch.randint(lo, hi, s))(0, N, E).to(torch.int64)
    rvec = (lambda *s: torch.randn(*s, dtype=torch.bfloat16) * 0.05)(E, 3).to(float)
    rn = (torch.linalg.norm(rvec, dim=-1, keepdim=True) + 1e-06).to(float)
    rhat = (rvec / rn).to(float)
    eps = torch.zeros((3, 3, 3), dtype=float)
    eps[0, 1, 2] = eps[1, 2, 0] = eps[2, 0, 1] = 1.0
    eps[0, 2, 1] = eps[2, 1, 0] = eps[1, 0, 2] = -1.0
    return {'x': _w((lambda *s: torch.randn(*s, dtype=torch.bfloat16) * 0.4)(N, 4 * C).to(float)), 'rhat': _w(rhat), 'e_attr': _w((lambda *s: torch.randn(*s, dtype=torch.bfloat16) * 0.4)(E, De).to(float)), 'src': _w(src), 'dst': _w(dst), 'w_rad': _w((lambda *s: torch.randn(*s, dtype=torch.bfloat16) * 0.4)(De, 5 * C).to(float)), 'w_si0': _w((lambda *s: torch.randn(*s, dtype=torch.bfloat16) * 0.4)(2 * C, C).to(float)), 'w_si1': _w((lambda *s: torch.randn(*s, dtype=torch.bfloat16) * 0.05)(3 * C, C).to(float)), 'cg_eps': _w(eps)}

def reference(x, rhat, e_attr, src, dst, w_rad, w_si0, w_si1, cg_eps):
    N = x.shape[0]
    C = w_si0.shape[1]
    E = rhat.shape[0]
    x0 = x[:, :C].clone()
    x1 = x[:, C:].reshape(N, 3, C)
    R = (e_attr @ w_rad).reshape(E, 5, C)
    f0 = x0[src]
    f1 = x1[src]
    Y1 = rhat
    p00_0 = f0 * R[:, 0, :]
    p11_0 = torch.einsum('ejc,ej->ec', f1, Y1) * R[:, 1, :]
    p01_1 = torch.einsum('ec,ej->ejc', f0, Y1) * R[:, 2, :][:, None, :]
    p10_1 = f1 * R[:, 3, :][:, None, :]
    p11_1 = torch.einsum('ijk,ekc,ej->eic', cg_eps, f1, Y1) * R[:, 4, :][:, None, :]
    m0 = torch.concatenate([p00_0, p11_0], axis=-1) @ w_si0
    m1 = torch.einsum('ejp,pc->ejc', torch.concatenate([p01_1, p10_1, p11_1], axis=-1), w_si1)
    agg0 = _segment_sum(m0, dst, N)
    agg1 = _segment_sum(m1.reshape(E, 3 * C), dst, N).reshape(N, 3, C)
    gate = _sigmoid(agg0)
    out1 = agg1 * gate[:, None, :]
    return torch.concatenate([agg0, out1.reshape(N, 3 * C)], axis=-1)
```

```asm
; @launch grid=(256,1,1) block=(512,1,1) lds=163840
.amdgcn_target "amdgcn-amd-amdhsa--gfx950"
.text
.globl gather_scatter__tensor_product_equiv_equiformer__graph_kernel
.p2align 8
.type gather_scatter__tensor_product_equiv_equiformer__graph_kernel,@function
gather_scatter__tensor_product_equiv_equiformer__graph_kernel:
    s_cmp_ge_u32 s2, 256
    s_cbranch_scc1 k2_end
    s_load_dwordx16 s[72:87], s[0:1], 8
    s_load_dwordx2 s[8:9], s[0:1], 88
    s_load_dwordx2 s[4:5], s[0:1], 0
    s_load_dwordx2 s[12:13], s[0:1], 72
    v_lshrrev_b32 v3, 6, v0
    s_mov_b32 s3, s2
    v_readfirstlane_b32 s16, v3
    s_and_b32 s32, s2, 7
    s_lshl_b32 s32, s32, 2
    s_lshr_b32 s32, 0x16270435, s32
    s_and_b32 s32, s32, 7
    s_lshr_b32 s2, s2, 3
    s_lshl_b32 s32, s32, 5
    s_or_b32 s2, s2, s32
    s_mov_b32 s6, 6400000
    s_mov_b32 s7, 0x00020000
    s_mov_b32 s10, 30932992
    s_mov_b32 s11, 0x00020000
    s_mov_b32 s14, 6400000
    s_mov_b32 s15, 0x00020000
    s_mov_b32 s17, 0
    s_mov_b32 s36, 0
    s_getpc_b64 s[32:33]
k2_pc:
    v_lshlrev_b32 v252, 5, v0
    v_min_u32 v252, k2_end-k2_pc, v252
    v_add_co_u32 v252, vcc, s32, v252
    v_mov_b32 v253, s33
    s_nop 0
    v_addc_co_u32 v253, vcc, 0, v253, vcc
    global_load_dword v255, v[252:253], off
k2_round:
    v_mbcnt_lo_u32_b32 v2, -1, 0
    v_mbcnt_hi_u32_b32 v2, -1, v2
    s_lshl_b32 s32, s16, 6
    v_add_u32 v3, s32, v2
    v_mov_b32 v12, 0
    v_lshlrev_b32 v14, 2, v3
    ds_write_b32 v14, v12 offset:0
    s_mul_i32 s32, s3, 12800
    s_mul_i32 s33, s3, 6400
    s_mul_i32 s34, s3, 19200
    v_lshl_add_u32 v4, v3, 4, s32
    v_lshl_add_u32 v5, v3, 3, s33
    v_mul_u32_u24 v6, 24, v3
    v_add_u32 v6, s34, v6
    v_add_u32 v7, 6400, v4
    v_add_u32 v8, 9600, v6
    v_cmp_gt_u32 vcc, 400, v3
    v_lshlrev_b32 v9, 4, v2
    s_mov_b64 s[20:21], vcc
    s_or_b32 s37, s36, s17
    s_cmp_ge_u32 s3, 250
    s_cselect_b64 vcc, 0, vcc
    s_waitcnt lgkmcnt(0)
    s_cbranch_vccz k2_noedge
    s_mov_b64 exec, vcc
    global_load_dwordx4 v[128:131], v4, s[78:79] nt
    global_load_dwordx4 v[132:135], v7, s[78:79] nt
    s_barrier
    global_load_dwordx4 v[136:139], v4, s[76:77] nt
    global_load_dwordx2 v[144:145], v5, s[74:75] nt
    global_load_dwordx4 v[148:151], v6, s[72:73] nt
    global_load_dwordx2 v[152:153], v6, s[72:73] offset:16 nt
    global_load_dwordx4 v[140:143], v7, s[76:77] nt
    global_load_dwordx2 v[146:147], v5, s[74:75] offset:3200 nt
    global_load_dwordx4 v[154:157], v8, s[72:73] nt
    global_load_dwordx2 v[158:159], v8, s[72:73] offset:16 nt
    s_mov_b64 exec, -1
    s_branch k2_init
k2_noedge:
    s_cmp_lg_u32 s16, 7
    s_cbranch_scc1 k2_nb1
    s_cmp_lg_u32 s37, 0
    s_cbranch_scc1 k2_noep
    s_load_dword s86, s[8:9], 0
k2_noep:
    v_min_u32 v99, 624, v9
    s_and_b32 s32, s2, 31
    s_mul_i32 s33, s32, 768
    s_lshl_b32 s32, s32, 9
    v_min_u32 v100, 3, v2
    v_min_u32 v101, 5, v2
    v_lshl_add_u32 v100, v100, 7, s32
    v_lshl_add_u32 v101, v101, 7, s33
    global_load_dwordx4 v[64:67], v99, s[80:81]
    global_load_dword v100, v100, s[82:83]
    global_load_dword v101, v101, s[84:85]
k2_nb1:
    s_barrier
k2_init:
    v_mov_b32 v4, -1
    v_mov_b32 v5, -1
    v_mov_b32 v6, -1
    v_mov_b32 v7, -1
    v_mov_b32 v13, 0
    v_lshlrev_b32 v8, 2, v14
    v_add_u32 v8, 106464, v8
    ds_write_b128 v8, v[4:7]
    ds_write_b128 v8, v[4:7] offset:8192
    ds_write_b128 v8, v[4:7] offset:16384
    s_lshl_b32 s32, s16, 12
    s_add_u32 s32, s32, 131040
    v_mov_b32 v16, 16
    v_mov_b32 v17, 16
    v_mov_b32 v18, 16
    v_mov_b32 v19, 16
    v_add_u32 v8, s32, v9
    ds_write_b128 v8, v[16:19]
    ds_write_b128 v8, v[16:19] offset:1024
    v_mov_b32 v8, 163808
    s_mov_b64 exec, 1
    ds_write_b64 v12, v[12:13] offset:3072
    ds_write_b64 v8, v[12:13]
    ds_write_b32 v8, v12 offset:8
    s_mov_b64 exec, -1
    v_lshl_add_u32 v17, v2, 5, s32
    v_lshl_add_u32 v18, v2, 2, s32
    v_lshl_add_u32 v19, v2, 3, s32
    s_lshl_b32 s32, s16, 9
    v_add_u32 v112, s32, v2
    s_lshl_b32 s32, s16, 5
    v_add_u32 v16, s32, v2
    s_mov_b32 s22, -1
    s_mov_b32 s23, 0
    s_mov_b32 s32, 96576
    v_lshl_add_u32 v10, v16, 2, s32
    v_mul_u32_u24 v16, 51200, v16
    v_add_u32 v16, s17, v16
    s_cmp_lg_u32 s36, 0
    s_cselect_b32 s18, 16777216, 0
    s_cselect_b32 s24, 384, 0
    v_mov_b32 v20, 0
    v_and_b32 v0, 15, v2
    v_lshlrev_b32 v0, 4, v0
    v_lshrrev_b32 v1, 4, v2
    v_and_b32 v15, 12, v2
    v_lshl_add_u32 v1, v15, 1, v1
    v_lshlrev_b32 v1, 2, v1
    v_lshl_or_b32 v1, v2, 30, v1
    v_and_b32 v15, 3, v2
    v_lshlrev_b32 v11, 3, v15
    v_lshlrev_b32 v5, 11, v15
    v_or_b32 v5, 0x2000, v5
    s_mov_b32 vcc_lo, 0x80808080
    s_mov_b32 vcc_hi, 0x88888888
    v_mov_b32 v15, 0x7f
    s_mov_b32 s26, 0x05040100
    v_cndmask_b32 v15, 0, v15, vcc
    s_mov_b32 s27, 0x07060302
    s_movk_i32 s28, 512
    s_movk_i32 s29, 4096
    s_mov_b32 s30, 131040
    s_mov_b32 s31, 0xffffc000
    s_lshr_b32 s25, s2, 2
    s_lshl_b32 s25, s25, 12
    s_add_u32 s25, s25, 13631488
    v_bfe_u32 v8, v2, 2, 2
    v_lshl_add_u32 v11, v8, 7, v11
    v_lshrrev_b32 v8, 4, v2
    v_lshl_add_u32 v11, v8, 10, v11
    v_lshlrev_b32 v13, 5, v8
    s_and_b32 s32, s16, 3
    s_lshl_b32 s32, s32, 5
    v_add_u32 v11, s32, v11
    v_mov_b32 v14, 4
    v_mov_b32 v4, 16
    v_add_u32 v113, 64, v112
    v_add_u32 v114, 128, v112
    v_add_u32 v115, 192, v112
    v_add_u32 v116, 256, v112
    v_add_u32 v117, 320, v112
    v_add_u32 v118, 384, v112
    v_add_u32 v119, 448, v112
    s_cmp_eq_u32 s16, 7
    s_cbranch_scc1 k2_w7a
    s_cmp_ge_u32 s3, 250
    s_cbranch_scc1 k2_b3
    s_mov_b64 exec, s[20:21]
    s_movk_i32 s32, 12288
    s_waitcnt vmcnt(9)
    v_lshlrev_b32_sdwa v160, 2, v128 dst_sel:DWORD dst_unused:UNUSED_PAD src0_sel:DWORD src1_sel:BYTE_0
    ds_add_rtn_u32 v168, v160, v4 offset:1024
    v_lshlrev_b32_sdwa v161, 2, v129 dst_sel:DWORD dst_unused:UNUSED_PAD src0_sel:DWORD src1_sel:BYTE_0
    ds_add_rtn_u32 v169, v161, v4 offset:1024
    v_lshlrev_b32_sdwa v162, 2, v130 dst_sel:DWORD dst_unused:UNUSED_PAD src0_sel:DWORD src1_sel:BYTE_0
    ds_add_rtn_u32 v170, v162, v4 offset:1024
    v_lshlrev_b32_sdwa v163, 2, v131 dst_sel:DWORD dst_unused:UNUSED_PAD src0_sel:DWORD src1_sel:BYTE_0
    ds_add_rtn_u32 v171, v163, v4 offset:1024
    s_waitcnt vmcnt(8)
    v_lshlrev_b32_sdwa v164, 2, v132 dst_sel:DWORD dst_unused:UNUSED_PAD src0_sel:DWORD src1_sel:BYTE_0
    ds_add_rtn_u32 v172, v164, v4 offset:1024
    v_lshlrev_b32_sdwa v165, 2, v133 dst_sel:DWORD dst_unused:UNUSED_PAD src0_sel:DWORD src1_sel:BYTE_0
    ds_add_rtn_u32 v173, v165, v4 offset:1024
    v_lshlrev_b32_sdwa v166, 2, v134 dst_sel:DWORD dst_unused:UNUSED_PAD src0_sel:DWORD src1_sel:BYTE_0
    ds_add_rtn_u32 v174, v166, v4 offset:1024
    v_lshlrev_b32_sdwa v167, 2, v135 dst_sel:DWORD dst_unused:UNUSED_PAD src0_sel:DWORD src1_sel:BYTE_0
    ds_add_rtn_u32 v175, v167, v4 offset:1024
    v_cmp_le_u32 s[40:41], s32, v128
    v_and_b32 v128, 0x3f00, v128
    v_cmp_le_u32 s[44:45], s32, v129
    v_and_b32 v129, 0x3f00, v129
    v_cmp_le_u32 s[48:49], s32, v130
    v_and_b32 v130, 0x3f00, v130
    v_cmp_le_u32 s[52:53], s32, v131
    v_and_b32 v131, 0x3f00, v131
    v_cmp_le_u32 s[56:57], s32, v132
    v_and_b32 v132, 0x3f00, v132
    v_cmp_le_u32 s[60:61], s32, v133
    v_and_b32 v133, 0x3f00, v133
    v_cmp_le_u32 s[64:65], s32, v134
    v_and_b32 v134, 0x3f00, v134
    v_cmp_le_u32 s[68:69], s32, v135
    v_and_b32 v135, 0x3f00, v135
    v_cndmask_b32 v6, 0, v5, s[40:41]
    v_lshl_or_b32 v128, v128, 2, v6
    v_cndmask_b32 v6, 0, v5, s[44:45]
    v_lshl_or_b32 v129, v129, 2, v6
    v_cndmask_b32 v6, 0, v5, s[48:49]
    v_lshl_or_b32 v130, v130, 2, v6
    v_cndmask_b32 v6, 0, v5, s[52:53]
    v_lshl_or_b32 v131, v131, 2, v6
    v_cndmask_b32 v6, 0, v5, s[56:57]
    v_lshl_or_b32 v132, v132, 2, v6
    v_cndmask_b32 v6, 0, v5, s[60:61]
    v_lshl_or_b32 v133, v133, 2, v6
    v_cndmask_b32 v6, 0, v5, s[64:65]
    v_lshl_or_b32 v134, v134, 2, v6
    v_cndmask_b32 v6, 0, v5, s[68:69]
    v_lshl_or_b32 v135, v135, 2, v6
    s_mov_b64 exec, -1
    s_branch k2_b2
k2_w7a:
    s_waitcnt lgkmcnt(0)
    s_mul_i32 s87, s86, 0x9E3779B1
    s_add_u32 s87, s87, 0x7F4A7C15
    v_mov_b32 v76, 0
    v_mov_b32 v77, 0
    v_mov_b32 v78, 0
    v_mov_b32 v79, s87
    s_mov_b32 s32, 0xffff0000
    ds_write_b32 v12, v79 offset:3088
    s_waitcnt vmcnt(2)
    v_lshlrev_b32 v68, 16, v64
    v_and_b32 v69, s32, v64
    v_lshlrev_b32 v70, 16, v65
    v_and_b32 v71, s32, v65
    v_lshlrev_b32 v72, 16, v66
    v_and_b32 v73, s32, v66
    v_lshlrev_b32 v74, 16, v67
    v_and_b32 v75, s32, v67
    v_lshlrev_b32 v99, 1, v99
    ds_write_b128 v99, v[68:71] offset:44096
    ds_write_b128 v99, v[72:75] offset:44112
    v_lshlrev_b32 v4, 12, v2
    s_lshl_b32 s32, s3, 4
    s_add_u32 s32, s32, 13631488
    s_cmp_ge_u32 s3, 250
    s_cbranch_scc1 k2_pub
k2_b2:
    s_waitcnt lgkmcnt(0)
    s_barrier
    ds_read_b128 v[176:179], v9 offset:1024
    ds_read_b32 v8, v12 offset:3088
    s_waitcnt lgkmcnt(1)
    v_add_u32 v181, v176, v177
    v_add_u32 v182, v181, v178
    v_add_u32 v6, v182, v179
    v_mov_b32 v183, v6
    s_nop 0
    v_add_u32_dpp v6, v6, v6 row_shr:1 row_mask:0xf bank_mask:0xf
    s_nop 1
    v_add_u32_dpp v6, v6, v6 row_shr:2 row_mask:0xf bank_mask:0xf
    s_nop 1
    v_add_u32_dpp v6, v6, v6 row_shr:4 row_mask:0xf bank_mask:0xf
    s_nop 1
    v_add_u32_dpp v6, v6, v6 row_shr:8 row_mask:0xf bank_mask:0xf
    s_nop 1
    v_add_u32_dpp v6, v6, v6 row_bcast:15 row_mask:0xa bank_mask:0xf
    s_nop 1
    v_add_u32_dpp v6, v6, v6 row_bcast:31 row_mask:0xc bank_mask:0xf
    v_sub_u32 v180, v6, v183
    v_add_u32 v183, v180, v182
    v_add_u32 v182, v180, v181
    v_add_u32 v181, v180, v176
    ds_write_b128 v9, v[180:183] offset:2048
    s_cmp_lg_u32 s16, 7
    s_cbranch_scc1 k2_n7b
    v_lshl_or_b32 v76, v181, 16, v180
    v_lshl_or_b32 v77, v183, 16, v182
    v_mov_b32 v78, v6
    s_waitcnt lgkmcnt(1)
k2_pub:
    s_cmp_lg_u32 s37, 0
    s_cbranch_scc1 k2_hpub
    buffer_store_dwordx4 v[76:79], v4, s[8:11], s32 offen sc1
    v_mov_b32 v80, 0
    v_mov_b32 v81, 0
    v_mov_b32 v82, 0
    v_mov_b32 v83, 0
k2_w7p:
    v_mov_b32 v96, v9
    s_mov_b32 m0, 3136
    s_nop 0
    global_load_lds_dwordx4 v96, s[82:83]
    global_load_lds_dwordx4 v96, s[82:83] offset:1024
    global_load_lds_dwordx4 v96, s[82:83] offset:2048
    global_load_lds_dwordx4 v96, s[82:83] offset:3072
    v_add_u32 v96, 4096, v96
    s_mov_b32 m0, 7232
    s_nop 0
    global_load_lds_dwordx4 v96, s[82:83]
    global_load_lds_dwordx4 v96, s[82:83] offset:1024
    global_load_lds_dwordx4 v96, s[82:83] offset:2048
    global_load_lds_dwordx4 v96, s[82:83] offset:3072
    v_add_u32 v96, 4096, v96
    s_mov_b32 m0, 11328
    s_nop 0
    global_load_lds_dwordx4 v96, s[82:83]
    global_load_lds_dwordx4 v96, s[82:83] offset:1024
    global_load_lds_dwordx4 v96, s[82:83] offset:2048
    global_load_lds_dwordx4 v96, s[82:83] offset:3072
    v_add_u32 v96, 4096, v96
    s_mov_b32 m0, 15424
    s_nop 0
    global_load_lds_dwordx4 v96, s[82:83]
    global_load_lds_dwordx4 v96, s[82:83] offset:1024
    global_load_lds_dwordx4 v96, s[82:83] offset:2048
    global_load_lds_dwordx4 v96, s[82:83] offset:3072
    v_mov_b32 v96, v9
    s_mov_b32 m0, 19520
    s_nop 0
    global_load_lds_dwordx4 v96, s[84:85]
    global_load_lds_dwordx4 v96, s[84:85] offset:1024
    global_load_lds_dwordx4 v96, s[84:85] offset:2048
    global_load_lds_dwordx4 v96, s[84:85] offset:3072
    v_add_u32 v96, 4096, v96
    s_mov_b32 m0, 23616
    s_nop 0
    global_load_lds_dwordx4 v96, s[84:85]
    global_load_lds_dwordx4 v96, s[84:85] offset:1024
    global_load_lds_dwordx4 v96, s[84:85] offset:2048
    global_load_lds_dwordx4 v96, s[84:85] offset:3072
    v_add_u32 v96, 4096, v96
    s_mov_b32 m0, 27712
    s_nop 0
    global_load_lds_dwordx4 v96, s[84:85]
    global_load_lds_dwordx4 v96, s[84:85] offset:1024
    global_load_lds_dwordx4 v96, s[84:85] offset:2048
    global_load_lds_dwordx4 v96, s[84:85] offset:3072
    v_add_u32 v96, 4096, v96
    s_mov_b32 m0, 31808
    s_nop 0
    global_load_lds_dwordx4 v96, s[84:85]
    global_load_lds_dwordx4 v96, s[84:85] offset:1024
    global_load_lds_dwordx4 v96, s[84:85] offset:2048
    global_load_lds_dwordx4 v96, s[84:85] offset:3072
    v_add_u32 v96, 4096, v96
    s_mov_b32 m0, 35904
    s_nop 0
    global_load_lds_dwordx4 v96, s[84:85]
    global_load_lds_dwordx4 v96, s[84:85] offset:1024
    global_load_lds_dwordx4 v96, s[84:85] offset:2048
    global_load_lds_dwordx4 v96, s[84:85] offset:3072
    v_add_u32 v96, 4096, v96
    s_mov_b32 m0, 40000
    s_nop 0
    global_load_lds_dwordx4 v96, s[84:85]
    global_load_lds_dwordx4 v96, s[84:85] offset:1024
    global_load_lds_dwordx4 v96, s[84:85] offset:2048
    global_load_lds_dwordx4 v96, s[84:85] offset:3072
    s_bitcmp1_b32 s2, 1
    s_cselect_b64 s[0:1], -1, 0
    s_lshl_b32 s33, s2, 4
    s_mov_b32 s32, 0x000f000f
    v_add_u32 v7, -63136, v18
    s_waitcnt lgkmcnt(0)
    s_barrier
    v_and_b32 v4, 2, v80
    v_cmp_eq_u32 s[40:41], 0, v4
    v_and_b32 v4, 2, v81
    v_cmp_eq_u32 s[44:45], 0, v4
    v_and_b32 v4, 2, v82
    v_cmp_eq_u32 s[48:49], 0, v4
    v_and_b32 v4, 2, v83
    v_cmp_eq_u32 s[52:53], 0, v4
k2_tpoll:
    buffer_load_dwordx4 v[64:67], v9, s[8:11], s25 offen offset:0 sc1
    buffer_load_dwordx4 v[68:71], v9, s[8:11], s25 offen offset:1024 sc1
    buffer_load_dwordx4 v[72:75], v9, s[8:11], s25 offen offset:2048 sc1
    buffer_load_dwordx4 v[76:79], v9, s[8:11], s25 offen offset:3072 sc1
    s_waitcnt vmcnt(3)
    v_or3_b32 v4, v64, v65, v66
    v_xor_b32 v5, s87, v67
    v_and_or_b32 v4, v4, s32, v5
    v_cndmask_b32 v64, v64, v65, s[0:1]
    v_cmp_eq_u32 vcc, 0, v4
    v_cndmask_b32 v65, v65, v66, s[0:1]
    s_and_b64 vcc, vcc, s[40:41]
    v_alignbit_b32 v64, v65, v64, s33
    s_andn2_b64 s[40:41], s[40:41], vcc
    v_or_b32 v64, 2, v64
    v_cndmask_b32 v80, v80, v64, vcc
    s_waitcnt vmcnt(2)
    v_or3_b32 v4, v68, v69, v70
    v_xor_b32 v5, s87, v71
    v_and_or_b32 v4, v4, s32, v5
    v_cndmask_b32 v68, v68, v69, s[0:1]
    v_cmp_eq_u32 vcc, 0, v4
    v_cndmask_b32 v69, v69, v70, s[0:1]
    s_and_b64 vcc, vcc, s[44:45]
    v_alignbit_b32 v68, v69, v68, s33
    s_andn2_b64 s[44:45], s[44:45], vcc
    v_or_b32 v68, 2, v68
    v_cndmask_b32 v81, v81, v68, vcc
    s_waitcnt vmcnt(1)
    v_or3_b32 v4, v72, v73, v74
    v_xor_b32 v5, s87, v75
    v_and_or_b32 v4, v4, s32, v5
    v_cndmask_b32 v72, v72, v73, s[0:1]
    v_cmp_eq_u32 vcc, 0, v4
    v_cndmask_b32 v73, v73, v74, s[0:1]
    s_and_b64 vcc, vcc, s[48:49]
    v_alignbit_b32 v72, v73, v72, s33
    s_andn2_b64 s[48:49], s[48:49], vcc
    v_or_b32 v72, 2, v72
    v_cndmask_b32 v82, v82, v72, vcc
    s_waitcnt vmcnt(0)
    v_or3_b32 v4, v76, v77, v78
    v_xor_b32 v5, s87, v79
    v_and_or_b32 v4, v4, s32, v5
    v_cndmask_b32 v76, v76, v77, s[0:1]
    v_cmp_eq_u32 vcc, 0, v4
    v_cndmask_b32 v77, v77, v78, s[0:1]
    s_and_b64 vcc, vcc, s[52:53]
    v_alignbit_b32 v76, v77, v76, s33
    s_andn2_b64 s[52:53], s[52:53], vcc
    v_or_b32 v76, 2, v76
    v_cndmask_b32 v83, v83, v76, vcc
    s_or_b64 s[42:43], s[40:41], s[44:45]
    s_or_b64 s[46:47], s[48:49], s[52:53]
    s_or_b64 vcc, s[42:43], s[46:47]
    s_cbranch_scc0 k2_tok
    s_add_u32 s24, s24, 1
    s_cmp_lt_u32 s24, 400
    s_cbranch_scc1 k2_tpoll
    s_ff1_i32_b64 s33, s[40:41]
    s_add_u32 s34, s33, 1
    s_cmp_lt_i32 s33, 0
    s_cselect_b32 s32, s32, s34
    s_ff1_i32_b64 s33, s[44:45]
    s_add_u32 s34, s33, 65
    s_cmp_lt_i32 s33, 0
    s_cselect_b32 s32, s32, s34
    s_ff1_i32_b64 s33, s[48:49]
    s_add_u32 s34, s33, 129
    s_cmp_lt_i32 s33, 0
    s_cselect_b32 s32, s32, s34
    s_ff1_i32_b64 s33, s[52:53]
    s_add_u32 s34, s33, 193
    s_cmp_lt_i32 s33, 0
    s_cselect_b32 s32, s32, s34
    v_mov_b32 v4, s32
    ds_write_b32 v12, v4 offset:3076
k2_tok:
    ds_write2st64_b32 v7, v80, v81 offset0:0 offset1:1
    ds_write2st64_b32 v7, v82, v83 offset0:2 offset1:3
    s_branch k2_b3b
k2_n7b:
    s_mov_b64 exec, s[20:21]
    ds_read_b32 v160, v160 offset:2048
    ds_read_b32 v161, v161 offset:2048
    ds_read_b32 v162, v162 offset:2048
    ds_read_b32 v163, v163 offset:2048
    ds_read_b32 v164, v164 offset:2048
    ds_read_b32 v165, v165 offset:2048
    ds_read_b32 v166, v166 offset:2048
    ds_read_b32 v167, v167 offset:2048
    s_mov_b32 s32, 0xffff0000
    s_mov_b32 s33, 5497558
    s_waitcnt lgkmcnt(9)
    v_readfirstlane_b32 s87, v8
    v_mov_b32 v195, v8
    v_mov_b32 v199, v8
    v_mov_b32 v203, v8
    v_mov_b32 v207, v8
    v_mov_b32 v211, v8
    v_mov_b32 v215, v8
    v_mov_b32 v219, v8
    v_mov_b32 v223, v8
    s_waitcnt vmcnt(4)
    v_lshlrev_b32 v184, 16, v144
    v_lshlrev_b32 v185, 16, v148
    v_and_b32 v186, s32, v148
    v_lshlrev_b32 v187, 16, v149
    v_mul_f32 v185, v184, v185
    v_mul_f32 v186, v184, v186
    v_mul_f32 v187, v184, v187
    v_cvt_pk_bf16_f32 v192, v184, v185
    v_cvt_pk_bf16_f32 v193, v186, v187
    v_mul_hi_u32_u24 v6, s33, v136
    v_lshl_or_b32 v6, v6, 6, v128
    v_lshl_or_b32 v194, v136, 16, v6
    s_waitcnt lgkmcnt(0)
    v_add_u32 v160, v160, v168
    ds_write_b128 v160, v[192:195] offset:45376
    v_and_b32 v184, s32, v144
    v_and_b32 v185, s32, v149
    v_lshlrev_b32 v186, 16, v150
    v_and_b32 v187, s32, v150
    v_mul_f32 v185, v184, v185
    v_mul_f32 v186, v184, v186
    v_mul_f32 v187, v184, v187
    v_cvt_pk_bf16_f32 v196, v184, v185
    v_cvt_pk_bf16_f32 v197, v186, v187
    v_mul_hi_u32_u24 v6, s33, v137
    v_lshl_or_b32 v6, v6, 6, v129
    v_lshl_or_b32 v198, v137, 16, v6
    v_add_u32 v161, v161, v169
    ds_write_b128 v161, v[196:199] offset:45376
    v_lshlrev_b32 v184, 16, v145
    v_lshlrev_b32 v185, 16, v151
    v_and_b32 v186, s32, v151
    v_lshlrev_b32 v187, 16, v152
    v_mul_f32 v185, v184, v185
    v_mul_f32 v186, v184, v186
    v_mul_f32 v187, v184, v187
    v_cvt_pk_bf16_f32 v200, v184, v185
    v_cvt_pk_bf16_f32 v201, v186, v187
    v_mul_hi_u32_u24 v6, s33, v138
    v_lshl_or_b32 v6, v6, 6, v130
    v_lshl_or_b32 v202, v138, 16, v6
    v_add_u32 v162, v162, v170
    ds_write_b128 v162, v[200:203] offset:45376
    v_and_b32 v184, s32, v145
    v_and_b32 v185, s32, v152
    v_lshlrev_b32 v186, 16, v153
    v_and_b32 v187, s32, v153
    v_mul_f32 v185, v184, v185
    v_mul_f32 v186, v184, v186
    v_mul_f32 v187, v184, v187
    v_cvt_pk_bf16_f32 v204, v184, v185
    v_cvt_pk_bf16_f32 v205, v186, v187
    v_mul_hi_u32_u24 v6, s33, v139
    v_lshl_or_b32 v6, v6, 6, v131
    v_lshl_or_b32 v206, v139, 16, v6
    v_add_u32 v163, v163, v171
    ds_write_b128 v163, v[204:207] offset:45376
    s_waitcnt vmcnt(0)
    v_lshlrev_b32 v184, 16, v146
    v_lshlrev_b32 v185, 16, v154
    v_and_b32 v186, s32, v154
    v_lshlrev_b32 v187, 16, v155
    v_mul_f32 v185, v184, v185
    v_mul_f32 v186, v184, v186
    v_mul_f32 v187, v184, v187
    v_cvt_pk_bf16_f32 v208, v184, v185
    v_cvt_pk_bf16_f32 v209, v186, v187
    v_mul_hi_u32_u24 v6, s33, v140
    v_lshl_or_b32 v6, v6, 6, v132
    v_lshl_or_b32 v210, v140, 16, v6
    v_add_u32 v164, v164, v172
    ds_write_b128 v164, v[208:211] offset:45376
    v_and_b32 v184, s32, v146
    v_and_b32 v185, s32, v155
    v_lshlrev_b32 v186, 16, v156
    v_and_b32 v187, s32, v156
    v_mul_f32 v185, v184, v185
    v_mul_f32 v186, v184, v186
    v_mul_f32 v187, v184, v187
    v_cvt_pk_bf16_f32 v212, v184, v185
    v_cvt_pk_bf16_f32 v213, v186, v187
    v_mul_hi_u32_u24 v6, s33, v141
    v_lshl_or_b32 v6, v6, 6, v133
    v_lshl_or_b32 v214, v141, 16, v6
    v_add_u32 v165, v165, v173
    ds_write_b128 v165, v[212:215] offset:45376
    v_lshlrev_b32 v184, 16, v147
    v_lshlrev_b32 v185, 16, v157
    v_and_b32 v186, s32, v157
    v_lshlrev_b32 v187, 16, v158
    v_mul_f32 v185, v184, v185
    v_mul_f32 v186, v184, v186
    v_mul_f32 v187, v184, v187
    v_cvt_pk_bf16_f32 v216, v184, v185
    v_cvt_pk_bf16_f32 v217, v186, v187
    v_mul_hi_u32_u24 v6, s33, v142
    v_lshl_or_b32 v6, v6, 6, v134
    v_lshl_or_b32 v218, v142, 16, v6
    v_add_u32 v166, v166, v174
    ds_write_b128 v166, v[216:219] offset:45376
    v_and_b32 v184, s32, v147
    v_and_b32 v185, s32, v158
    v_lshlrev_b32 v186, 16, v159
    v_and_b32 v187, s32, v159
    v_mul_f32 v185, v184, v185
    v_mul_f32 v186, v184, v186
    v_mul_f32 v187, v184, v187
    v_cvt_pk_bf16_f32 v220, v184, v185
    v_cvt_pk_bf16_f32 v221, v186, v187
    v_mul_hi_u32_u24 v6, s33, v143
    v_lshl_or_b32 v6, v6, 6, v135
    v_lshl_or_b32 v222, v143, 16, v6
    v_add_u32 v167, v167, v175
    ds_write_b128 v167, v[220:223] offset:45376
k2_b3:
    s_sub_u32 s32, 6, s16
    s_mul_i32 s32, s32, 7168
    s_mov_b64 exec, -1
    v_add_u32 v8, s32, v9
    s_mul_i32 s32, s3, 51200
    s_add_u32 s32, s32, 4096
    s_add_u32 s32, s32, s18
    s_add_u32 s33, s32, 4096
    s_cmp_ge_u32 s3, 250
    s_waitcnt lgkmcnt(0)
    s_barrier
    s_cbranch_scc1 k2_np
    ds_read_b128 v[192:195], v8 offset:45376
    ds_read_b128 v[196:199], v8 offset:46400
    ds_read_b128 v[200:203], v8 offset:47424
    ds_read_b128 v[204:207], v8 offset:48448
    ds_read_b128 v[208:211], v8 offset:49472
    ds_read_b128 v[212:215], v8 offset:50496
    ds_read_b128 v[216:219], v8 offset:51520
    ds_read_b128 v[220:223], v8 offset:52544
    s_cmp_lg_u32 s36, 0
    s_cbranch_scc1 k2_hst
    s_cmp_lg_u32 s16, 0
    s_waitcnt lgkmcnt(7)
    buffer_store_dwordx4 v[192:195], v8, s[8:11], s32 offen offset:0 sc1
    s_waitcnt lgkmcnt(6)
    buffer_store_dwordx4 v[196:199], v8, s[8:11], s32 offen offset:1024 sc1
    s_waitcnt lgkmcnt(5)
    buffer_store_dwordx4 v[200:203], v8, s[8:11], s32 offen offset:2048 sc1
    s_waitcnt lgkmcnt(4)
    buffer_store_dwordx4 v[204:207], v8, s[8:11], s32 offen offset:3072 sc1
    s_waitcnt lgkmcnt(3)
    buffer_store_dwordx4 v[208:211], v8, s[8:11], s33 offen offset:0 sc1
    s_waitcnt lgkmcnt(2)
    buffer_store_dwordx4 v[212:215], v8, s[8:11], s33 offen offset:1024 sc1
    s_waitcnt lgkmcnt(1)
    buffer_store_dwordx4 v[216:219], v8, s[8:11], s33 offen offset:2048 sc1
    s_cbranch_scc1 k2_hop
    s_waitcnt lgkmcnt(0)
    buffer_store_dwordx4 v[220:223], v8, s[8:11], s33 offen offset:3072 sc1
k2_hop:
k2_b3b:
    s_waitcnt lgkmcnt(0)
    s_barrier
    s_mov_b64 exec, s[22:23]
    ds_read_b32 v20, v10
    s_mov_b64 exec, -1
    ds_read_b32 v21, v12 offset:3076
    s_cmp_lg_u32 s17, 0
    s_cbranch_scc1 k2_now
    s_mov_b32 s32, 0xffff0000
    ds_read_b64_tr_b16 v[24:25], v11 offset:3136
    ds_read_b64_tr_b16 v[26:27], v11 offset:3648
    ds_read_b128 v[128:131], v13 offset:44096
    ds_read_b128 v[132:135], v13 offset:44112
    ds_read_b64_tr_b16 v[28:29], v11 offset:7232
    ds_read_b64_tr_b16 v[30:31], v11 offset:7744
    ds_read_b128 v[136:139], v13 offset:44224
    ds_read_b128 v[140:143], v13 offset:44240
    ds_read_b64_tr_b16 v[32:33], v11 offset:11328
    ds_read_b64_tr_b16 v[34:35], v11 offset:11840
    ds_read_b128 v[144:147], v13 offset:44352
    ds_read_b128 v[148:151], v13 offset:44368
    s_waitcnt lgkmcnt(8)
    ds_read_b64_tr_b16 v[36:37], v11 offset:15424
    ds_read_b64_tr_b16 v[38:39], v11 offset:15936
    ds_read_b128 v[152:155], v13 offset:44480
    ds_read_b128 v[156:159], v13 offset:44496
    v_lshlrev_b32 v208, 16, v24
    v_and_b32 v209, s32, v24
    v_lshlrev_b32 v210, 16, v25
    v_and_b32 v211, s32, v25
    v_lshlrev_b32 v212, 16, v26
    v_and_b32 v213, s32, v26
    v_lshlrev_b32 v214, 16, v27
    v_and_b32 v215, s32, v27
    v_pk_mul_f32 v[208:209], v[208:209], v[128:129]
    v_pk_mul_f32 v[210:211], v[210:211], v[130:131]
    v_pk_mul_f32 v[212:213], v[212:213], v[132:133]
    v_pk_mul_f32 v[214:215], v[214:215], v[134:135]
    v_cvt_pk_bf16_f32 v24, v208, v209
    v_cvt_pk_bf16_f32 v25, v210, v211
    v_cvt_pk_bf16_f32 v26, v212, v213
    v_cvt_pk_bf16_f32 v27, v214, v215
    s_waitcnt lgkmcnt(8)
    ds_read_b64_tr_b16 v[40:41], v11 offset:19520
    ds_read_b64_tr_b16 v[42:43], v11 offset:20032
    ds_read_b128 v[160:163], v13 offset:44608
    ds_read_b128 v[164:167], v13 offset:44624
    v_lshlrev_b32 v208, 16, v28
    v_and_b32 v209, s32, v28
    v_lshlrev_b32 v210, 16, v29
    v_and_b32 v211, s32, v29
    v_lshlrev_b32 v212, 16, v30
    v_and_b32 v213, s32, v30
    v_lshlrev_b32 v214, 16, v31
    v_and_b32 v215, s32, v31
    v_pk_mul_f32 v[208:209], v[208:209], v[136:137]
    v_pk_mul_f32 v[210:211], v[210:211], v[138:139]
    v_pk_mul_f32 v[212:213], v[212:213], v[140:141]
    v_pk_mul_f32 v[214:215], v[214:215], v[142:143]
    v_cvt_pk_bf16_f32 v28, v208, v209
    v_cvt_pk_bf16_f32 v29, v210, v211
    v_cvt_pk_bf16_f32 v30, v212, v213
    v_cvt_pk_bf16_f32 v31, v214, v215
    s_waitcnt lgkmcnt(8)
    ds_read_b64_tr_b16 v[44:45], v11 offset:23616
    ds_read_b64_tr_b16 v[46:47], v11 offset:24128
    ds_read_b128 v[168:171], v13 offset:44736
    ds_read_b128 v[172:175], v13 offset:44752
    v_lshlrev_b32 v208, 16, v32
    v_and_b32 v209, s32, v32
    v_lshlrev_b32 v210, 16, v33
    v_and_b32 v211, s32, v33
    v_lshlrev_b32 v212, 16, v34
    v_and_b32 v213, s32, v34
    v_lshlrev_b32 v214, 16, v35
    v_and_b32 v215, s32, v35
    v_pk_mul_f32 v[208:209], v[208:209], v[144:145]
    v_pk_mul_f32 v[210:211], v[210:211], v[146:147]
    v_pk_mul_f32 v[212:213], v[212:213], v[148:149]
    v_pk_mul_f32 v[214:215], v[214:215], v[150:151]
    v_cvt_pk_bf16_f32 v32, v208, v209
    v_cvt_pk_bf16_f32 v33, v210, v211
    v_cvt_pk_bf16_f32 v34, v212, v213
    v_cvt_pk_bf16_f32 v35, v214, v215
    s_waitcnt lgkmcnt(8)
    ds_read_b64_tr_b16 v[48:49], v11 offset:27712
    ds_read_b64_tr_b16 v[50:51], v11 offset:28224
    ds_read_b128 v[176:179], v13 offset:44864
    ds_read_b128 v[180:183], v13 offset:44880
    v_lshlrev_b32 v208, 16, v36
    v_and_b32 v209, s32, v36
    v_lshlrev_b32 v210, 16, v37
    v_and_b32 v211, s32, v37
    v_lshlrev_b32 v212, 16, v38
    v_and_b32 v213, s32, v38
    v_lshlrev_b32 v214, 16, v39
    v_and_b32 v215, s32, v39
    v_pk_mul_f32 v[208:209], v[208:209], v[152:153]
    v_pk_mul_f32 v[210:211], v[210:211], v[154:155]
    v_pk_mul_f32 v[212:213], v[212:213], v[156:157]
    v_pk_mul_f32 v[214:215], v[214:215], v[158:159]
    v_cvt_pk_bf16_f32 v36, v208, v209
    v_cvt_pk_bf16_f32 v37, v210, v211
    v_cvt_pk_bf16_f32 v38, v212, v213
    v_cvt_pk_bf16_f32 v39, v214, v215
    s_waitcnt lgkmcnt(8)
    ds_read_b64_tr_b16 v[52:53], v11 offset:31808
    ds_read_b64_tr_b16 v[54:55], v11 offset:32320
    ds_read_b128 v[184:187], v13 offset:44992
    ds_read_b128 v[188:191], v13 offset:45008
    v_lshlrev_b32 v208, 16, v40
    v_and_b32 v209, s32, v40
    v_lshlrev_b32 v210, 16, v41
    v_and_b32 v211, s32, v41
    v_lshlrev_b32 v212, 16, v42
    v_and_b32 v213, s32, v42
    v_lshlrev_b32 v214, 16, v43
    v_and_b32 v215, s32, v43
    v_pk_mul_f32 v[208:209], v[208:209], v[160:161]
    v_pk_mul_f32 v[210:211], v[210:211], v[162:163]
    v_pk_mul_f32 v[212:213], v[212:213], v[164:165]
    v_pk_mul_f32 v[214:215], v[214:215], v[166:167]
    v_cvt_pk_bf16_f32 v40, v208, v209
    v_cvt_pk_bf16_f32 v41, v210, v211
    v_cvt_pk_bf16_f32 v42, v212, v213
    v_cvt_pk_bf16_f32 v43, v214, v215
    s_waitcnt lgkmcnt(8)
    ds_read_b64_tr_b16 v[56:57], v11 offset:35904
    ds_read_b64_tr_b16 v[58:59], v11 offset:36416
    ds_read_b128 v[192:195], v13 offset:45120
    ds_read_b128 v[196:199], v13 offset:45136
    v_lshlrev_b32 v208, 16, v44
    v_and_b32 v209, s32, v44
    v_lshlrev_b32 v210, 16, v45
    v_and_b32 v211, s32, v45
    v_lshlrev_b32 v212, 16, v46
    v_and_b32 v213, s32, v46
    v_lshlrev_b32 v214, 16, v47
    v_and_b32 v215, s32, v47
    v_pk_mul_f32 v[208:209], v[208:209], v[168:169]
    v_pk_mul_f32 v[210:211], v[210:211], v[170:171]
    v_pk_mul_f32 v[212:213], v[212:213], v[172:173]
    v_pk_mul_f32 v[214:215], v[214:215], v[174:175]
    v_cvt_pk_bf16_f32 v44, v208, v209
    v_cvt_pk_bf16_f32 v45, v210, v211
    v_cvt_pk_bf16_f32 v46, v212, v213
    v_cvt_pk_bf16_f32 v47, v214, v215
    s_waitcnt lgkmcnt(8)
    ds_read_b64_tr_b16 v[60:61], v11 offset:40000
    ds_read_b64_tr_b16 v[62:63], v11 offset:40512
    ds_read_b128 v[200:203], v13 offset:45248
    ds_read_b128 v[204:207], v13 offset:45264
    v_lshlrev_b32 v208, 16, v48
    v_and_b32 v209, s32, v48
    v_lshlrev_b32 v210, 16, v49
    v_and_b32 v211, s32, v49
    v_lshlrev_b32 v212, 16, v50
    v_and_b32 v213, s32, v50
    v_lshlrev_b32 v214, 16, v51
    v_and_b32 v215, s32, v51
    v_pk_mul_f32 v[208:209], v[208:209], v[176:177]
    v_pk_mul_f32 v[210:211], v[210:211], v[178:179]
    v_pk_mul_f32 v[212:213], v[212:213], v[180:181]
    v_pk_mul_f32 v[214:215], v[214:215], v[182:183]
    v_cvt_pk_bf16_f32 v48, v208, v209
    v_cvt_pk_bf16_f32 v49, v210, v211
    v_cvt_pk_bf16_f32 v50, v212, v213
    v_cvt_pk_bf16_f32 v51, v214, v215
    s_waitcnt lgkmcnt(8)
    v_lshlrev_b32 v208, 16, v52
    v_and_b32 v209, s32, v52
    v_lshlrev_b32 v210, 16, v53
    v_and_b32 v211, s32, v53
    v_lshlrev_b32 v212, 16, v54
    v_and_b32 v213, s32, v54
    v_lshlrev_b32 v214, 16, v55
    v_and_b32 v215, s32, v55
    v_pk_mul_f32 v[208:209], v[208:209], v[184:185]
    v_pk_mul_f32 v[210:211], v[210:211], v[186:187]
    v_pk_mul_f32 v[212:213], v[212:213], v[188:189]
    v_pk_mul_f32 v[214:215], v[214:215], v[190:191]
    v_cvt_pk_bf16_f32 v52, v208, v209
    v_cvt_pk_bf16_f32 v53, v210, v211
    v_cvt_pk_bf16_f32 v54, v212, v213
    v_cvt_pk_bf16_f32 v55, v214, v215
    s_waitcnt lgkmcnt(4)
    v_lshlrev_b32 v208, 16, v56
    v_and_b32 v209, s32, v56
    v_lshlrev_b32 v210, 16, v57
    v_and_b32 v211, s32, v57
    v_lshlrev_b32 v212, 16, v58
    v_and_b32 v213, s32, v58
    v_lshlrev_b32 v214, 16, v59
    v_and_b32 v215, s32, v59
    v_pk_mul_f32 v[208:209], v[208:209], v[192:193]
    v_pk_mul_f32 v[210:211], v[210:211], v[194:195]
    v_pk_mul_f32 v[212:213], v[212:213], v[196:197]
    v_pk_mul_f32 v[214:215], v[214:215], v[198:199]
    v_cvt_pk_bf16_f32 v56, v208, v209
    v_cvt_pk_bf16_f32 v57, v210, v211
    v_cvt_pk_bf16_f32 v58, v212, v213
    v_cvt_pk_bf16_f32 v59, v214, v215
    s_waitcnt lgkmcnt(0)
    v_lshlrev_b32 v208, 16, v60
    v_and_b32 v209, s32, v60
    v_lshlrev_b32 v210, 16, v61
    v_and_b32 v211, s32, v61
    v_lshlrev_b32 v212, 16, v62
    v_and_b32 v213, s32, v62
    v_lshlrev_b32 v214, 16, v63
    v_and_b32 v215, s32, v63
    v_pk_mul_f32 v[208:209], v[208:209], v[200:201]
    v_pk_mul_f32 v[210:211], v[210:211], v[202:203]
    v_pk_mul_f32 v[212:213], v[212:213], v[204:205]
    v_pk_mul_f32 v[214:215], v[214:215], v[206:207]
    v_cvt_pk_bf16_f32 v60, v208, v209
    v_cvt_pk_bf16_f32 v61, v210, v211
    v_cvt_pk_bf16_f32 v62, v212, v213
    v_cvt_pk_bf16_f32 v63, v214, v215
k2_now:
    s_waitcnt lgkmcnt(0)
    v_cmp_ne_u32 vcc, 0, v21
    v_and_b32 v4, 1, v20
    v_and_b32 v20, -4, v20
    s_cbranch_vccnz k2_p1h
    v_lshl_add_u32 v16, v4, 24, v16
    v_sub_u32_sdwa v4, v20, v20 dst_sel:DWORD dst_unused:UNUSED_PAD src0_sel:WORD_1 src1_sel:WORD_0
    v_mov_b32 v5, v4
    v_add_u32_sdwa v6, v16, v20 dst_sel:DWORD dst_unused:UNUSED_PAD src0_sel:DWORD src1_sel:WORD_0
    s_movk_i32 s33, 8192
    v_add_u32_dpp v5, v5, v5 row_shr:1 row_mask:0xf bank_mask:0xf
    s_nop 1
    v_add_u32_dpp v5, v5, v5 row_shr:2 row_mask:0xf bank_mask:0xf
    s_nop 1
    v_add_u32_dpp v5, v5, v5 row_shr:4 row_mask:0xf bank_mask:0xf
    s_nop 1
    v_add_u32_dpp v5, v5, v5 row_shr:8 row_mask:0xf bank_mask:0xf
    s_nop 1
    v_add_u32_dpp v5, v5, v5 row_bcast:15 row_mask:0xa bank_mask:0xf
    s_lshl_b32 s32, s16, 12
    s_add_u32 s32, s32, 131040
    v_sub_u32 v4, v5, v4
    v_readlane_b32 s19, v5, 31
    v_sub_u32 v6, v6, v4
    v_subrev_u32 v4, s17, v4
    v_subrev_u32 v5, s17, v5
    v_med3_i32 v4, v4, 0, s33
    v_med3_i32 v5, v5, 0, s33
    v_lshrrev_b32 v4, 2, v4
    v_lshrrev_b32 v5, 2, v5
    v_add_u32 v4, s32, v4
    v_add_u32 v5, s32, v5
    s_mov_b64 exec, s[22:23]
    ds_add_u32 v4, v6
    ds_sub_u32 v5, v6
    s_mov_b64 exec, -1
    ds_read_b128 v[64:67], v17
    ds_read_b128 v[68:71], v17 offset:16
    s_sub_u32 s19, s19, s17
    s_cmp_le_i32 s19, 8192
    s_cbranch_scc1 k2_nomore
    ds_write_b32 v12, v14 offset:3072
k2_nomore:
    v_cmp_gt_i32 s[40:41], s19, v9
    s_sub_u32 s19, s19, 1024
    v_cmp_gt_i32 s[44:45], s19, v9
    s_sub_u32 s19, s19, 1024
    v_cmp_gt_i32 s[48:49], s19, v9
    s_sub_u32 s19, s19, 1024
    v_cmp_gt_i32 s[52:53], s19, v9
    s_sub_u32 s19, s19, 1024
    v_cmp_gt_i32 s[56:57], s19, v9
    s_sub_u32 s19, s19, 1024
    v_cmp_gt_i32 s[60:61], s19, v9
    s_sub_u32 s19, s19, 1024
    v_cmp_gt_i32 s[64:65], s19, v9
    s_sub_u32 s19, s19, 1024
    v_cmp_gt_i32 s[68:69], s19, v9
    s_waitcnt lgkmcnt(0)
    v_add_u32 v65, v65, v64
    v_add_u32 v66, v66, v65
    v_add_u32 v67, v67, v66
    v_add_u32 v68, v68, v67
    v_add_u32 v69, v69, v68
    v_add_u32 v70, v70, v69
    v_add_u32 v71, v71, v70
    v_mov_b32 v4, v71
    s_nop 0
    v_add_u32_dpp v71, v71, v71 row_shr:1 row_mask:0xf bank_mask:0xf
    s_nop 1
    v_add_u32_dpp v71, v71, v71 row_shr:2 row_mask:0xf bank_mask:0xf
    s_nop 1
    v_add_u32_dpp v71, v71, v71 row_shr:4 row_mask:0xf bank_mask:0xf
    s_nop 1
    v_add_u32_dpp v71, v71, v71 row_shr:8 row_mask:0xf bank_mask:0xf
    s_nop 1
    v_add_u32_dpp v71, v71, v71 row_bcast:15 row_mask:0xa bank_mask:0xf
    s_nop 1
    v_add_u32_dpp v71, v71, v71 row_bcast:31 row_mask:0xc bank_mask:0xf
    v_sub_u32 v4, v71, v4
    v_add_u32 v64, v64, v4
    v_add_u32 v65, v65, v4
    v_add_u32 v66, v66, v4
    v_add_u32 v67, v67, v4
    v_add_u32 v68, v68, v4
    v_add_u32 v69, v69, v4
    v_add_u32 v70, v70, v4
    ds_write_b128 v17, v[64:67]
    ds_write_b128 v17, v[68:71] offset:16
    ds_read2st64_b32 v[96:97], v18 offset0:0 offset1:1
    ds_read2st64_b32 v[98:99], v18 offset0:2 offset1:3
    ds_read2st64_b32 v[100:101], v18 offset0:4 offset1:5
    ds_read2st64_b32 v[102:103], v18 offset0:6 offset1:7
    s_mov_b64 s[42:43], s[40:41]
    s_mov_b64 s[46:47], s[44:45]
    s_mov_b64 s[50:51], s[48:49]
    s_mov_b64 s[54:55], s[52:53]
    s_mov_b64 s[58:59], s[56:57]
    s_mov_b64 s[62:63], s[60:61]
    s_mov_b64 s[66:67], s[64:65]
    s_mov_b64 s[70:71], s[68:69]
    s_movk_i32 s25, 4080
    s_mov_b32 s35, 0xc000003f
    s_mov_b32 s24, 0
    s_waitcnt vmcnt(0)
    s_waitcnt lgkmcnt(3)
    s_mov_b64 exec, s[42:43]
    buffer_load_dwordx4 v[64:67], v96, s[8:11], s25 offen sc1
    s_mov_b64 exec, s[46:47]
    buffer_load_dwordx4 v[68:71], v97, s[8:11], s25 offen sc1
    s_waitcnt lgkmcnt(2)
    s_mov_b64 exec, s[50:51]
    buffer_load_dwordx4 v[72:75], v98, s[8:11], s25 offen sc1
    s_mov_b64 exec, s[54:55]
    buffer_load_dwordx4 v[76:79], v99, s[8:11], s25 offen sc1
    s_waitcnt lgkmcnt(1)
    s_mov_b64 exec, s[58:59]
    buffer_load_dwordx4 v[80:83], v100, s[8:11], s25 offen sc1
    s_mov_b64 exec, s[62:63]
    buffer_load_dwordx4 v[84:87], v101, s[8:11], s25 offen sc1
    s_waitcnt lgkmcnt(0)
    s_mov_b64 exec, s[66:67]
    buffer_load_dwordx4 v[88:91], v102, s[8:11], s25 offen sc1
    s_mov_b64 exec, s[70:71]
    buffer_load_dwordx4 v[92:95], v103, s[8:11], s25 offen sc1
    s_branch k2_dchk
k2_dpoll:
    s_mov_b64 exec, s[42:43]
    buffer_load_dwordx4 v[64:67], v96, s[8:11], s25 offen sc1
    s_mov_b64 exec, s[46:47]
    buffer_load_dwordx4 v[68:71], v97, s[8:11], s25 offen sc1
    s_mov_b64 exec, s[50:51]
    buffer_load_dwordx4 v[72:75], v98, s[8:11], s25 offen sc1
    s_mov_b64 exec, s[54:55]
    buffer_load_dwordx4 v[76:79], v99, s[8:11], s25 offen sc1
    s_mov_b64 exec, s[58:59]
    buffer_load_dwordx4 v[80:83], v100, s[8:11], s25 offen sc1
    s_mov_b64 exec, s[62:63]
    buffer_load_dwordx4 v[84:87], v101, s[8:11], s25 offen sc1
    s_mov_b64 exec, s[66:67]
    buffer_load_dwordx4 v[88:91], v102, s[8:11], s25 offen sc1
    s_mov_b64 exec, s[70:71]
    buffer_load_dwordx4 v[92:95], v103, s[8:11], s25 offen sc1
k2_dchk:
    s_mov_b64 exec, s[42:43]
    s_waitcnt vmcnt(7)
    v_xor_b32 v4, s87, v67
    v_and_or_b32 v4, v66, s35, v4
    v_cmpx_eq_u32 vcc, 0, v4
    v_bfe_u32 v104, v66, 4, 10
    s_andn2_b64 s[42:43], s[42:43], vcc
    ds_add_rtn_u32 v120, v104, v14 offset:0
    v_and_or_b32 v112, v66, s31, v112
    ds_write_b64 v19, v[64:65] offset:0
    s_mov_b64 exec, s[46:47]
    s_waitcnt vmcnt(6)
    v_xor_b32 v4, s87, v71
    v_and_or_b32 v4, v70, s35, v4
    v_cmpx_eq_u32 vcc, 0, v4
    v_bfe_u32 v105, v70, 4, 10
    s_andn2_b64 s[46:47], s[46:47], vcc
    ds_add_rtn_u32 v121, v105, v14 offset:0
    v_and_or_b32 v113, v70, s31, v113
    ds_write_b64 v19, v[68:69] offset:512
    s_or_b64 s[20:21], s[42:43], s[46:47]
    s_mov_b64 exec, s[50:51]
    s_waitcnt vmcnt(5)
    v_xor_b32 v4, s87, v75
    v_and_or_b32 v4, v74, s35, v4
    v_cmpx_eq_u32 vcc, 0, v4
    v_bfe_u32 v106, v74, 4, 10
    s_andn2_b64 s[50:51], s[50:51], vcc
    ds_add_rtn_u32 v122, v106, v14 offset:0
    v_and_or_b32 v114, v74, s31, v114
    ds_write_b64 v19, v[72:73] offset:1024
    s_or_b64 s[20:21], s[20:21], s[50:51]
    s_mov_b64 exec, s[54:55]
    s_waitcnt vmcnt(4)
    v_xor_b32 v4, s87, v79
    v_and_or_b32 v4, v78, s35, v4
    v_cmpx_eq_u32 vcc, 0, v4
    v_bfe_u32 v107, v78, 4, 10
    s_andn2_b64 s[54:55], s[54:55], vcc
    ds_add_rtn_u32 v123, v107, v14 offset:0
    v_and_or_b32 v115, v78, s31, v115
    ds_write_b64 v19, v[76:77] offset:1536
    s_or_b64 s[20:21], s[20:21], s[54:55]
    s_mov_b64 exec, s[58:59]
    s_waitcnt vmcnt(3)
    v_xor_b32 v4, s87, v83
    v_and_or_b32 v4, v82, s35, v4
    v_cmpx_eq_u32 vcc, 0, v4
    v_bfe_u32 v108, v82, 4, 10
    s_andn2_b64 s[58:59], s[58:59], vcc
    ds_add_rtn_u32 v124, v108, v14 offset:0
    v_and_or_b32 v116, v82, s31, v116
    ds_write_b64 v19, v[80:81] offset:2048
    s_or_b64 s[20:21], s[20:21], s[58:59]
    s_mov_b64 exec, s[62:63]
    s_waitcnt vmcnt(2)
    v_xor_b32 v4, s87, v87
    v_and_or_b32 v4, v86, s35, v4
    v_cmpx_eq_u32 vcc, 0, v4
    v_bfe_u32 v109, v86, 4, 10
    s_andn2_b64 s[62:63], s[62:63], vcc
    ds_add_rtn_u32 v125, v109, v14 offset:0
    v_and_or_b32 v117, v86, s31, v117
    ds_write_b64 v19, v[84:85] offset:2560
    s_or_b64 s[20:21], s[20:21], s[62:63]
    s_mov_b64 exec, s[66:67]
    s_waitcnt vmcnt(1)
    v_xor_b32 v4, s87, v91
    v_and_or_b32 v4, v90, s35, v4
    v_cmpx_eq_u32 vcc, 0, v4
    v_bfe_u32 v110, v90, 4, 10
    s_andn2_b64 s[66:67], s[66:67], vcc
    ds_add_rtn_u32 v126, v110, v14 offset:0
    v_and_or_b32 v118, v90, s31, v118
    ds_write_b64 v19, v[88:89] offset:3072
    s_or_b64 s[20:21], s[20:21], s[66:67]
    s_mov_b64 exec, s[70:71]
    s_waitcnt vmcnt(0)
    v_xor_b32 v4, s87, v95
    v_and_or_b32 v4, v94, s35, v4
    v_cmpx_eq_u32 vcc, 0, v4
    v_bfe_u32 v111, v94, 4, 10
    s_andn2_b64 s[70:71], s[70:71], vcc
    ds_add_rtn_u32 v127, v111, v14 offset:0
    v_and_or_b32 v119, v94, s31, v119
    ds_write_b64 v19, v[92:93] offset:3584
    s_or_b64 s[20:21], s[20:21], s[70:71]
    s_cbranch_scc0 k2_p1e
    s_add_u32 s24, s24, 1
    s_cmp_lt_u32 s24, 0x20000
    s_cbranch_scc1 k2_dpoll
k2_p1e:
    s_mov_b64 exec, 0x1ffffff
    s_lshl_b32 s35, s3, 3
    s_add_u32 s35, s35, s16
    s_mul_i32 s35, s35, 3200
    v_lshlrev_b32 v96, 3, v9
    buffer_load_dword v96, v96, s[4:7], s35 offen
    s_mov_b64 exec, -1
    s_mov_b64 exec, -1
    s_lshl_b32 s32, s16, 3
    s_add_u32 s33, s32, 4
    s_add_u32 s34, s32, 7
    s_add_u32 s35, s32, 3
    s_waitcnt lgkmcnt(0)
    s_barrier
    ds_read_b128 v[4:7], v9 offset:0
    ds_read_b32 v20, v12 offset:3072
    s_waitcnt lgkmcnt(1)
    v_add_u32 v5, v4, v5
    v_add_u32 v6, v5, v6
    v_add_u32 v7, v6, v7
    s_nop 1
    v_add_u32_dpp v10, v7, v7 quad_perm:[1,0,3,2] row_mask:0xf bank_mask:0xf
    s_nop 1
    v_add_u32_dpp v10, v10, v10 quad_perm:[2,3,0,1] row_mask:0xf bank_mask:0xf
    s_nop 1
    v_add_u32_dpp v10, v10, v10 row_half_mirror row_mask:0x3 bank_mask:0xf
    v_sub_u32 v10, 0, v10
    v_and_b32 v22, v15, v10
    v_add_u32 v7, v7, v22
    v_mov_b32 v10, v7
    s_nop 1
    v_add_u32_dpp v10, v10, v10 row_shr:1 row_mask:0xf bank_mask:0xf
    s_nop 1
    v_add_u32_dpp v10, v10, v10 row_shr:2 row_mask:0xf bank_mask:0xf
    s_nop 1
    v_add_u32_dpp v10, v10, v10 row_shr:4 row_mask:0xf bank_mask:0xf
    s_nop 1
    v_add_u32_dpp v10, v10, v10 row_shr:8 row_mask:0xf bank_mask:0xf
    s_nop 1
    v_add_u32_dpp v10, v10, v10 row_bcast:15 row_mask:0xa bank_mask:0xf
    s_nop 1
    v_add_u32_dpp v10, v10, v10 row_bcast:31 row_mask:0xc bank_mask:0xf
    s_nop 0
    v_readlane_b32 s19, v10, 63
    v_sub_u32 v22, v10, v22
    v_sub_u32 v10, v10, v7
    s_sub_u32 s19, 131040, s19
    v_add_u32 v10, s19, v10
    v_add_u32 v7, v10, v6
    v_add_u32 v6, v10, v5
    v_add_u32 v5, v10, v4
    v_mov_b32 v4, v10
    v_add_u32 v22, s19, v22
    v_mov_b32_dpp v23, v10 quad_perm:[0,0,0,0] row_mask:0xf bank_mask:0xf
    s_nop 1
    v_add_u32_dpp v23, v22, v23 quad_perm:[3,3,3,3] row_mask:0xf bank_mask:0xf
    s_nop 1
    v_subrev_u32_dpp v4, v5, v23 quad_perm:[0,1,2,3] row_mask:0x3 bank_mask:0x5
    v_subrev_u32_dpp v5, v6, v23 quad_perm:[0,1,2,3] row_mask:0x3 bank_mask:0x5
    v_subrev_u32_dpp v6, v7, v23 quad_perm:[0,1,2,3] row_mask:0x3 bank_mask:0x5
    v_subrev_u32_dpp v7, v22, v23 quad_perm:[0,1,2,3] row_mask:0x3 bank_mask:0x5
    ds_write_b128 v9, v[4:7] offset:2048
    v_readlane_b32 s20, v10, s32
    v_readlane_b32 s22, v10, s33
    v_readlane_b32 s21, v22, s35
    v_readlane_b32 s23, v22, s34
    s_waitcnt lgkmcnt(1)
    v_readfirstlane_b32 s18, v20
    ds_read_b32 v104, v104 offset:2048
    ds_read_b32 v105, v105 offset:2048
    ds_read_b32 v106, v106 offset:2048
    ds_read_b32 v107, v107 offset:2048
    ds_read_b32 v108, v108 offset:2048
    ds_read_b32 v109, v109 offset:2048
    ds_read_b32 v110, v110 offset:2048
    ds_read_b32 v111, v111 offset:2048
    s_mov_b64 exec, s[40:41]
    s_waitcnt lgkmcnt(7)
    v_add_u32 v104, v104, v120
    ds_write_b32 v104, v112
    s_mov_b64 exec, s[44:45]
    s_waitcnt lgkmcnt(7)
    v_add_u32 v105, v105, v121
    ds_write_b32 v105, v113
    s_mov_b64 exec, s[48:49]
    s_waitcnt lgkmcnt(7)
    v_add_u32 v106, v106, v122
    ds_write_b32 v106, v114
    s_mov_b64 exec, s[52:53]
    s_waitcnt lgkmcnt(7)
    v_add_u32 v107, v107, v123
    ds_write_b32 v107, v115
    s_mov_b64 exec, s[56:57]
    s_waitcnt lgkmcnt(7)
    v_add_u32 v108, v108, v124
    ds_write_b32 v108, v116
    s_mov_b64 exec, s[60:61]
    s_waitcnt lgkmcnt(7)
    v_add_u32 v109, v109, v125
    ds_write_b32 v109, v117
    s_mov_b64 exec, s[64:65]
    s_waitcnt lgkmcnt(7)
    v_add_u32 v110, v110, v126
    ds_write_b32 v110, v118
    s_mov_b64 exec, s[68:69]
    s_waitcnt lgkmcnt(7)
    v_add_u32 v111, v111, v127
    ds_write_b32 v111, v119
    s_mov_b64 exec, -1
    s_cmp_ge_u32 s16, 4
    s_cbranch_scc1 k2_hsel
    s_sub_u32 s32, s21, s20
    s_mov_b32 s43, s21
    s_max_u32 s32, s32, 4
    s_sub_u32 s32, s32, 4
    s_andn2_b32 s32, s32, 127
    s_add_u32 s21, s20, s32
    s_mov_b32 s24, s21
    s_add_u32 s22, s21, 128
    s_sub_u32 s45, s21, 128
    s_movk_i32 s46, -128
    s_branch k2_sel
k2_hsel:
    s_cmp_lt_u32 s20, s21
    s_cselect_b32 s25, 0, 1
    s_cselect_b32 s24, s20, s22
    s_cselect_b32 s32, 128, 0
    s_add_u32 s20, s20, s32
    s_sub_u32 s32, 128, s32
    s_add_u32 s22, s22, s32
    s_mov_b32 s45, s20
    s_movk_i32 s46, 128
k2_sel:
    s_mov_b32 s40, s18
    s_waitcnt lgkmcnt(0)
    s_barrier
    s_cmp_lt_u32 s16, 4
    s_cselect_b64 vcc, -1, 0
    s_cbranch_scc1 k2_lop
    s_setprio 1
k2_lop:
    s_cmp_ge_u32 s24, s23
    s_cbranch_scc1 k2_wz
    v_add_u32_sdwa v2, s24, v1 dst_sel:DWORD dst_unused:UNUSED_PAD src0_sel:DWORD src1_sel:WORD_0
    v_and_or_b32 v8, v1, 12, s24
    ds_read2_b32 v[16:17], v8 offset0:0 offset1:4
    ds_read2_b32 v[18:19], v8 offset0:8 offset1:12
    ds_read2_b32 v[20:21], v8 offset0:16 offset1:20
    ds_read2_b32 v[22:23], v8 offset0:24 offset1:28
    ds_read2_b32 v[2:3], v2 offset0:0 offset1:4
    s_waitcnt lgkmcnt(1)
    v_mad_u32_u16 v16, v16, s28, v0 op_sel:[1,0,0,0]
    buffer_load_dwordx4 v[64:67], v16, s[4:7], 0 offen
    v_mad_u32_u16 v17, v17, s28, v0 op_sel:[1,0,0,0]
    buffer_load_dwordx4 v[68:71], v17, s[4:7], 0 offen
    v_mad_u32_u16 v18, v18, s28, v0 op_sel:[1,0,0,0]
    buffer_load_dwordx4 v[72:75], v18, s[4:7], 0 offen
    v_mad_u32_u16 v19, v19, s28, v0 op_sel:[1,0,0,0]
    buffer_load_dwordx4 v[76:79], v19, s[4:7], 0 offen
    v_mad_u32_u16 v20, v20, s28, v0 op_sel:[1,0,0,0]
    buffer_load_dwordx4 v[80:83], v20, s[4:7], 0 offen
    v_mad_u32_u16 v21, v21, s28, v0 op_sel:[1,0,0,0]
    buffer_load_dwordx4 v[84:87], v21, s[4:7], 0 offen
    v_mad_u32_u16 v22, v22, s28, v0 op_sel:[1,0,0,0]
    buffer_load_dwordx4 v[88:91], v22, s[4:7], 0 offen
    v_mad_u32_u16 v23, v23, s28, v0 op_sel:[1,0,0,0]
    buffer_load_dwordx4 v[92:95], v23, s[4:7], 0 offen
    buffer_load_dwordx4 v[96:99], v16, s[4:7], 0 offen offset:256
    buffer_load_dwordx4 v[100:103], v17, s[4:7], 0 offen offset:256
    buffer_load_dwordx4 v[104:107], v18, s[4:7], 0 offen offset:256
    buffer_load_dwordx4 v[108:111], v19, s[4:7], 0 offen offset:256
    buffer_load_dwordx4 v[112:115], v20, s[4:7], 0 offen offset:256
    buffer_load_dwordx4 v[116:119], v21, s[4:7], 0 offen offset:256
    buffer_load_dwordx4 v[120:123], v22, s[4:7], 0 offen offset:256
    buffer_load_dwordx4 v[124:127], v23, s[4:7], 0 offen offset:256
    s_waitcnt lgkmcnt(0)
    v_xor_b32_sdwa v2, v2, v1 dst_sel:DWORD dst_unused:UNUSED_PAD src0_sel:WORD_0 src1_sel:WORD_1
    v_xor_b32_sdwa v3, v3, v1 dst_sel:DWORD dst_unused:UNUSED_PAD src0_sel:WORD_0 src1_sel:WORD_1
    v_min_u32 v2, s29, v2
    v_min_u32 v3, s29, v3
    v_lshl_add_u32 v2, v2, 3, s30
    v_lshl_add_u32 v3, v3, 3, s30
    s_cmp_ge_u32 s16, 4
    s_cbranch_scc1 k2_nse
    v_add_u32_sdwa v8, s24, v1 dst_sel:DWORD dst_unused:UNUSED_PAD src0_sel:DWORD src1_sel:WORD_0
    v_mov_b32 v9, 163808
    v_cmp_gt_u32 vcc, s43, v8
    v_add_u32 v8, 16, v8
    s_nop 0
    v_cndmask_b32 v10, v2, v9, vcc
    v_cndmask_b32 v2, v9, v2, vcc
    v_cmp_gt_u32 vcc, s43, v8
    ds_read_b64_tr_b16 v[24:25], v10
    s_nop 0
    v_cndmask_b32 v11, v3, v9, vcc
    v_cndmask_b32 v3, v9, v3, vcc
    ds_read_b64_tr_b16 v[26:27], v11
k2_nse:
    ds_read_b64_tr_b16 v[4:5], v2
    ds_read_b64_tr_b16 v[6:7], v3
k2_wz:
    s_cmp_lg_u32 s17, 0
    s_cbranch_scc1 k2_noz
    v_mov_b64 v[128:129], 0
    v_mov_b64 v[130:131], 0
    v_mov_b64 v[132:133], 0
    v_mov_b64 v[134:135], 0
    v_mov_b64 v[136:137], 0
    v_mov_b64 v[138:139], 0
    v_mov_b64 v[140:141], 0
    v_mov_b64 v[142:143], 0
    v_mov_b64 v[144:145], 0
    v_mov_b64 v[146:147], 0
    v_mov_b64 v[148:149], 0
    v_mov_b64 v[150:151], 0
    v_mov_b64 v[152:153], 0
    v_mov_b64 v[154:155], 0
    v_mov_b64 v[156:157], 0
    v_mov_b64 v[158:159], 0
    v_mov_b64 v[160:161], 0
    v_mov_b64 v[162:163], 0
    v_mov_b64 v[164:165], 0
    v_mov_b64 v[166:167], 0
    v_mov_b64 v[168:169], 0
    v_mov_b64 v[170:171], 0
    v_mov_b64 v[172:173], 0
    v_mov_b64 v[174:175], 0
    v_mov_b64 v[176:177], 0
    v_mov_b64 v[178:179], 0
    v_mov_b64 v[180:181], 0
    v_mov_b64 v[182:183], 0
    v_mov_b64 v[184:185], 0
    v_mov_b64 v[186:187], 0
    v_mov_b64 v[188:189], 0
    v_mov_b64 v[190:191], 0
    v_mov_b64 v[192:193], 0
    v_mov_b64 v[194:195], 0
    v_mov_b64 v[196:197], 0
    v_mov_b64 v[198:199], 0
    v_mov_b64 v[200:201], 0
    v_mov_b64 v[202:203], 0
    v_mov_b64 v[204:205], 0
    v_mov_b64 v[206:207], 0
    v_mov_b64 v[208:209], 0
    v_mov_b64 v[210:211], 0
    v_mov_b64 v[212:213], 0
    v_mov_b64 v[214:215], 0
    v_mov_b64 v[216:217], 0
    v_mov_b64 v[218:219], 0
    v_mov_b64 v[220:221], 0
    v_mov_b64 v[222:223], 0
    v_mov_b64 v[224:225], 0
    v_mov_b64 v[226:227], 0
    v_mov_b64 v[228:229], 0
    v_mov_b64 v[230:231], 0
    v_mov_b64 v[232:233], 0
    v_mov_b64 v[234:235], 0
    v_mov_b64 v[236:237], 0
    v_mov_b64 v[238:239], 0
    v_mov_b64 v[240:241], 0
    v_mov_b64 v[242:243], 0
    v_mov_b64 v[244:245], 0
    v_mov_b64 v[246:247], 0
    v_mov_b64 v[248:249], 0
    v_mov_b64 v[250:251], 0
    v_mov_b64 v[252:253], 0
    v_mov_b64 v[254:255], 0
    s_xor_b32 s32, s16, 7
    s_or_b32 s32, s32, s2
    s_or_b32 s32, s32, s36
    s_cbranch_scc1 k2_noz
    s_mov_b64 exec, 1
    v_mov_b32 v8, s87
    buffer_store_dword v8, off, s[8:11], 0 sc1
    s_mov_b64 exec, -1
k2_noz:
    s_cmp_ge_u32 s24, s23
    s_cbranch_scc1 k2_done
    s_cmp_ge_u32 s16, 4
    s_cbranch_scc1 k2_hdis
    s_mov_b32 s25, 0
    s_cmp_lt_u32 s20, s21
    s_cbranch_scc1 k2_m0
    s_mov_b32 s24, 106592
    s_cmp_lt_u32 s22, s23
    s_cbranch_scc0 k2_mb
    s_mov_b32 s24, s22
    s_add_u32 s22, s22, 128
    s_mov_b32 s25, 1
    s_branch k2_mb
k2_m0:
    s_mov_b32 s24, s45
    s_add_u32 s45, s45, s46
    s_add_u32 s20, s20, 128
k2_mb:
    v_add_u32_sdwa v2, s24, v1 dst_sel:DWORD dst_unused:UNUSED_PAD src0_sel:DWORD src1_sel:WORD_0
    v_and_or_b32 v8, v1, 12, s24
    ds_read2_b32 v[16:17], v8 offset0:0 offset1:4
    ds_read2_b32 v[18:19], v8 offset0:8 offset1:12
    ds_read2_b32 v[20:21], v8 offset0:16 offset1:20
    ds_read2_b32 v[22:23], v8 offset0:24 offset1:28
    ds_read2_b32 v[2:3], v2 offset0:0 offset1:4
    s_waitcnt vmcnt(8)
    v_perm_b32 v8, v72, v64, s26
    v_perm_b32 v9, v88, v80, s26
    v_perm_b32 v10, v76, v68, s26
    v_perm_b32 v11, v92, v84, s26
    v_perm_b32 v12, v72, v64, s27
    v_perm_b32 v13, v88, v80, s27
    v_perm_b32 v14, v76, v68, s27
    v_perm_b32 v15, v92, v84, s27
    s_waitcnt lgkmcnt(5)
    v_mfma_f32_16x16x32_bf16 v[128:131], v[4:7], v[8:11], v[128:131]
    v_mfma_f32_16x16x32_bf16 v[192:195], v[24:27], v[8:11], v[192:195]
    v_perm_b32 v8, v73, v65, s26
    v_perm_b32 v9, v89, v81, s26
    v_perm_b32 v10, v77, v69, s26
    v_perm_b32 v11, v93, v85, s26
    v_mfma_f32_16x16x32_bf16 v[132:135], v[4:7], v[12:15], v[132:135]
    v_mfma_f32_16x16x32_bf16 v[196:199], v[24:27], v[12:15], v[196:199]
    v_perm_b32 v12, v73, v65, s27
    v_perm_b32 v13, v89, v81, s27
    v_perm_b32 v14, v77, v69, s27
    v_perm_b32 v15, v93, v85, s27
    v_mfma_f32_16x16x32_bf16 v[136:139], v[4:7], v[8:11], v[136:139]
    v_mfma_f32_16x16x32_bf16 v[200:203], v[24:27], v[8:11], v[200:203]
    v_perm_b32 v8, v74, v66, s26
    v_perm_b32 v9, v90, v82, s26
    v_perm_b32 v10, v78, v70, s26
    v_perm_b32 v11, v94, v86, s26
    v_mfma_f32_16x16x32_bf16 v[140:143], v[4:7], v[12:15], v[140:143]
    v_mfma_f32_16x16x32_bf16 v[204:207], v[24:27], v[12:15], v[204:207]
    v_perm_b32 v12, v74, v66, s27
    v_perm_b32 v13, v90, v82, s27
    v_perm_b32 v14, v78, v70, s27
    v_perm_b32 v15, v94, v86, s27
    v_mfma_f32_16x16x32_bf16 v[144:147], v[4:7], v[8:11], v[144:147]
    v_mfma_f32_16x16x32_bf16 v[208:211], v[24:27], v[8:11], v[208:211]
    v_perm_b32 v8, v75, v67, s26
    v_perm_b32 v9, v91, v83, s26
    v_perm_b32 v10, v79, v71, s26
    v_perm_b32 v11, v95, v87, s26
    v_mfma_f32_16x16x32_bf16 v[148:151], v[4:7], v[12:15], v[148:151]
    v_mfma_f32_16x16x32_bf16 v[212:215], v[24:27], v[12:15], v[212:215]
    v_perm_b32 v12, v75, v67, s27
    v_perm_b32 v13, v91, v83, s27
    v_perm_b32 v14, v79, v71, s27
    v_perm_b32 v15, v95, v87, s27
    v_mfma_f32_16x16x32_bf16 v[152:155], v[4:7], v[8:11], v[152:155]
    v_mfma_f32_16x16x32_bf16 v[216:219], v[24:27], v[8:11], v[216:219]
    v_mfma_f32_16x16x32_bf16 v[156:159], v[4:7], v[12:15], v[156:159]
    v_mfma_f32_16x16x32_bf16 v[220:223], v[24:27], v[12:15], v[220:223]
    s_waitcnt lgkmcnt(0)
    v_mad_u32_u16 v16, v16, s28, v0 op_sel:[1,0,0,0]
    buffer_load_dwordx4 v[64:67], v16, s[4:7], 0 offen
    v_mad_u32_u16 v17, v17, s28, v0 op_sel:[1,0,0,0]
    buffer_load_dwordx4 v[68:71], v17, s[4:7], 0 offen
    v_mad_u32_u16 v18, v18, s28, v0 op_sel:[1,0,0,0]
    buffer_load_dwordx4 v[72:75], v18, s[4:7], 0 offen
    v_mad_u32_u16 v19, v19, s28, v0 op_sel:[1,0,0,0]
    buffer_load_dwordx4 v[76:79], v19, s[4:7], 0 offen
    v_mad_u32_u16 v20, v20, s28, v0 op_sel:[1,0,0,0]
    buffer_load_dwordx4 v[80:83], v20, s[4:7], 0 offen
    v_mad_u32_u16 v21, v21, s28, v0 op_sel:[1,0,0,0]
    buffer_load_dwordx4 v[84:87], v21, s[4:7], 0 offen
    v_mad_u32_u16 v22, v22, s28, v0 op_sel:[1,0,0,0]
    buffer_load_dwordx4 v[88:91], v22, s[4:7], 0 offen
    v_mad_u32_u16 v23, v23, s28, v0 op_sel:[1,0,0,0]
    buffer_load_dwordx4 v[92:95], v23, s[4:7], 0 offen
    v_xor_b32_sdwa v2, v2, v1 dst_sel:DWORD dst_unused:UNUSED_PAD src0_sel:WORD_0 src1_sel:WORD_1
    v_xor_b32_sdwa v3, v3, v1 dst_sel:DWORD dst_unused:UNUSED_PAD src0_sel:WORD_0 src1_sel:WORD_1
    v_min_u32 v2, s29, v2
    v_min_u32 v3, s29, v3
    v_lshl_add_u32 v2, v2, 3, s30
    v_lshl_add_u32 v3, v3, 3, s30
    s_waitcnt vmcnt(8)
    v_perm_b32 v8, v104, v96, s26
    v_perm_b32 v9, v120, v112, s26
    v_perm_b32 v10, v108, v100, s26
    v_perm_b32 v11, v124, v116, s26
    v_perm_b32 v12, v104, v96, s27
    v_perm_b32 v13, v120, v112, s27
    v_perm_b32 v14, v108, v100, s27
    v_perm_b32 v15, v124, v116, s27
    v_mfma_f32_16x16x32_bf16 v[160:163], v[4:7], v[8:11], v[160:163]
    v_mfma_f32_16x16x32_bf16 v[224:227], v[24:27], v[8:11], v[224:227]
    v_perm_b32 v8, v105, v97, s26
    v_perm_b32 v9, v121, v113, s26
    v_perm_b32 v10, v109, v101, s26
    v_perm_b32 v11, v125, v117, s26
    v_mfma_f32_16x16x32_bf16 v[164:167], v[4:7], v[12:15], v[164:167]
    v_mfma_f32_16x16x32_bf16 v[228:231], v[24:27], v[12:15], v[228:231]
    v_perm_b32 v12, v105, v97, s27
    v_perm_b32 v13, v121, v113, s27
    v_perm_b32 v14, v109, v101, s27
    v_perm_b32 v15, v125, v117, s27
    v_mfma_f32_16x16x32_bf16 v[168:171], v[4:7], v[8:11], v[168:171]
    v_mfma_f32_16x16x32_bf16 v[232:235], v[24:27], v[8:11], v[232:235]
    v_perm_b32 v8, v106, v98, s26
    v_perm_b32 v9, v122, v114, s26
    v_perm_b32 v10, v110, v102, s26
    v_perm_b32 v11, v126, v118, s26
    v_mfma_f32_16x16x32_bf16 v[172:175], v[4:7], v[12:15], v[172:175]
    v_mfma_f32_16x16x32_bf16 v[236:239], v[24:27], v[12:15], v[236:239]
    v_perm_b32 v12, v106, v98, s27
    v_perm_b32 v13, v122, v114, s27
    v_perm_b32 v14, v110, v102, s27
    v_perm_b32 v15, v126, v118, s27
    v_mfma_f32_16x16x32_bf16 v[176:179], v[4:7], v[8:11], v[176:179]
    v_mfma_f32_16x16x32_bf16 v[240:243], v[24:27], v[8:11], v[240:243]
    v_perm_b32 v8, v107, v99, s26
    v_perm_b32 v9, v123, v115, s26
    v_perm_b32 v10, v111, v103, s26
    v_perm_b32 v11, v127, v119, s26
    v_mfma_f32_16x16x32_bf16 v[180:183], v[4:7], v[12:15], v[180:183]
    v_mfma_f32_16x16x32_bf16 v[244:247], v[24:27], v[12:15], v[244:247]
    v_perm_b32 v12, v107, v99, s27
    v_perm_b32 v13, v123, v115, s27
    v_perm_b32 v14, v111, v103, s27
    v_perm_b32 v15, v127, v119, s27
    v_mfma_f32_16x16x32_bf16 v[184:187], v[4:7], v[8:11], v[184:187]
    v_mfma_f32_16x16x32_bf16 v[248:251], v[24:27], v[8:11], v[248:251]
    v_mfma_f32_16x16x32_bf16 v[188:191], v[4:7], v[12:15], v[188:191]
    v_mfma_f32_16x16x32_bf16 v[252:255], v[24:27], v[12:15], v[252:255]
    buffer_load_dwordx4 v[96:99], v16, s[4:7], 0 offen offset:256
    buffer_load_dwordx4 v[100:103], v17, s[4:7], 0 offen offset:256
    buffer_load_dwordx4 v[104:107], v18, s[4:7], 0 offen offset:256
    buffer_load_dwordx4 v[108:111], v19, s[4:7], 0 offen offset:256
    buffer_load_dwordx4 v[112:115], v20, s[4:7], 0 offen offset:256
    buffer_load_dwordx4 v[116:119], v21, s[4:7], 0 offen offset:256
    buffer_load_dwordx4 v[120:123], v22, s[4:7], 0 offen offset:256
    buffer_load_dwordx4 v[124:127], v23, s[4:7], 0 offen offset:256
    ds_read_b64_tr_b16 v[4:5], v2
    ds_read_b64_tr_b16 v[6:7], v3
k2_hdis:
    s_cmp_eq_u32 s25, 0
    s_cbranch_scc0 k2_stub1
k2_stub0:
    s_add_u32 s32, s22, 256
    s_cmp_lt_u32 s32, s23
    s_cbranch_scc1 k2_oth0
    s_cmp_lt_u32 s20, s21
    s_cbranch_scc1 k2_same0
    s_cmp_lt_u32 s22, s23
    s_cbranch_scc1 k2_oth0
    s_branch k2_tail0
k2_same0:
    s_mov_b32 s24, s45
    s_add_u32 s45, s45, s46
    s_sub_u32 s38, s21, s20
    s_add_u32 s20, s20, 128
    s_mov_b32 s25, 0
    s_branch k2_body0
k2_oth0:
    s_mov_b32 s24, s22
    s_sub_u32 s38, s23, s22
    s_add_u32 s22, s22, 128
    s_mov_b32 s25, 1
k2_body0:
    v_add_u32_sdwa v2, s24, v1 dst_sel:DWORD dst_unused:UNUSED_PAD src0_sel:DWORD src1_sel:WORD_0
    v_and_or_b32 v8, v1, 12, s24
    ds_read2_b32 v[16:17], v8 offset0:0 offset1:4
    ds_read2_b32 v[18:19], v8 offset0:8 offset1:12
    ds_read2_b32 v[20:21], v8 offset0:16 offset1:20
    ds_read2_b32 v[22:23], v8 offset0:24 offset1:28
    ds_read2_b32 v[2:3], v2 offset0:0 offset1:4
    s_waitcnt vmcnt(8)
    v_perm_b32 v8, v72, v64, s26
    v_perm_b32 v9, v88, v80, s26
    v_perm_b32 v10, v76, v68, s26
    v_perm_b32 v11, v92, v84, s26
    v_perm_b32 v12, v72, v64, s27
    v_perm_b32 v13, v88, v80, s27
    v_perm_b32 v14, v76, v68, s27
    v_perm_b32 v15, v92, v84, s27
    s_waitcnt lgkmcnt(5)
    v_mfma_f32_16x16x32_bf16 v[128:131], v[4:7], v[8:11], v[128:131]
    v_perm_b32 v8, v73, v65, s26
    v_perm_b32 v9, v89, v81, s26
    v_perm_b32 v10, v77, v69, s26
    v_perm_b32 v11, v93, v85, s26
    v_mfma_f32_16x16x32_bf16 v[132:135], v[4:7], v[12:15], v[132:135]
    v_perm_b32 v12, v73, v65, s27
    v_perm_b32 v13, v89, v81, s27
    v_perm_b32 v14, v77, v69, s27
    v_perm_b32 v15, v93, v85, s27
    v_mfma_f32_16x16x32_bf16 v[136:139], v[4:7], v[8:11], v[136:139]
    v_perm_b32 v8, v74, v66, s26
    v_perm_b32 v9, v90, v82, s26
    v_perm_b32 v10, v78, v70, s26
    v_perm_b32 v11, v94, v86, s26
    v_mfma_f32_16x16x32_bf16 v[140:143], v[4:7], v[12:15], v[140:143]
    v_perm_b32 v12, v74, v66, s27
    v_perm_b32 v13, v90, v82, s27
    v_perm_b32 v14, v78, v70, s27
    v_perm_b32 v15, v94, v86, s27
    v_mfma_f32_16x16x32_bf16 v[144:147], v[4:7], v[8:11], v[144:147]
    v_perm_b32 v8, v75, v67, s26
    v_perm_b32 v9, v91, v83, s26
    v_perm_b32 v10, v79, v71, s26
    v_perm_b32 v11, v95, v87, s26
    v_mfma_f32_16x16x32_bf16 v[148:151], v[4:7], v[12:15], v[148:151]
    v_perm_b32 v12, v75, v67, s27
    v_perm_b32 v13, v91, v83, s27
    v_perm_b32 v14, v79, v71, s27
    v_perm_b32 v15, v95, v87, s27
    v_mfma_f32_16x16x32_bf16 v[152:155], v[4:7], v[8:11], v[152:155]
    s_nop 0
    v_mfma_f32_16x16x32_bf16 v[156:159], v[4:7], v[12:15], v[156:159]
    s_cmp_le_u32 s38, 112
    s_waitcnt lgkmcnt(0)
    s_cbranch_scc1 k2_sa0
    v_mad_u32_u16 v16, v16, s28, v0 op_sel:[1,0,0,0]
    buffer_load_dwordx4 v[64:67], v16, s[4:7], 0 offen
    v_mad_u32_u16 v17, v17, s28, v0 op_sel:[1,0,0,0]
    buffer_load_dwordx4 v[68:71], v17, s[4:7], 0 offen
    v_mad_u32_u16 v18, v18, s28, v0 op_sel:[1,0,0,0]
    buffer_load_dwordx4 v[72:75], v18, s[4:7], 0 offen
    v_mad_u32_u16 v19, v19, s28, v0 op_sel:[1,0,0,0]
    buffer_load_dwordx4 v[76:79], v19, s[4:7], 0 offen
    v_mad_u32_u16 v20, v20, s28, v0 op_sel:[1,0,0,0]
    buffer_load_dwordx4 v[80:83], v20, s[4:7], 0 offen
    v_mad_u32_u16 v21, v21, s28, v0 op_sel:[1,0,0,0]
    buffer_load_dwordx4 v[84:87], v21, s[4:7], 0 offen
    v_mad_u32_u16 v22, v22, s28, v0 op_sel:[1,0,0,0]
    buffer_load_dwordx4 v[88:91], v22, s[4:7], 0 offen
    v_mad_u32_u16 v23, v23, s28, v0 op_sel:[1,0,0,0]
    buffer_load_dwordx4 v[92:95], v23, s[4:7], 0 offen
k2_ra0:
    v_xor_b32_sdwa v2, v2, v1 dst_sel:DWORD dst_unused:UNUSED_PAD src0_sel:WORD_0 src1_sel:WORD_1
    v_xor_b32_sdwa v3, v3, v1 dst_sel:DWORD dst_unused:UNUSED_PAD src0_sel:WORD_0 src1_sel:WORD_1
    v_min_u32 v2, s29, v2
    v_min_u32 v3, s29, v3
    v_lshl_add_u32 v2, v2, 3, s30
    v_lshl_add_u32 v3, v3, 3, s30
    s_waitcnt vmcnt(8)
    v_perm_b32 v8, v104, v96, s26
    v_perm_b32 v9, v120, v112, s26
    v_perm_b32 v10, v108, v100, s26
    v_perm_b32 v11, v124, v116, s26
    v_perm_b32 v12, v104, v96, s27
    v_perm_b32 v13, v120, v112, s27
    v_perm_b32 v14, v108, v100, s27
    v_perm_b32 v15, v124, v116, s27
    v_mfma_f32_16x16x32_bf16 v[160:163], v[4:7], v[8:11], v[160:163]
    v_perm_b32 v8, v105, v97, s26
    v_perm_b32 v9, v121, v113, s26
    v_perm_b32 v10, v109, v101, s26
    v_perm_b32 v11, v125, v117, s26
    v_mfma_f32_16x16x32_bf16 v[164:167], v[4:7], v[12:15], v[164:167]
    v_perm_b32 v12, v105, v97, s27
    v_perm_b32 v13, v121, v113, s27
    v_perm_b32 v14, v109, v101, s27
    v_perm_b32 v15, v125, v117, s27
    v_mfma_f32_16x16x32_bf16 v[168:171], v[4:7], v[8:11], v[168:171]
    v_perm_b32 v8, v106, v98, s26
    v_perm_b32 v9, v122, v114, s26
    v_perm_b32 v10, v110, v102, s26
    v_perm_b32 v11, v126, v118, s26
    v_mfma_f32_16x16x32_bf16 v[172:175], v[4:7], v[12:15], v[172:175]
    v_perm_b32 v12, v106, v98, s27
    v_perm_b32 v13, v122, v114, s27
    v_perm_b32 v14, v110, v102, s27
    v_perm_b32 v15, v126, v118, s27
    v_mfma_f32_16x16x32_bf16 v[176:179], v[4:7], v[8:11], v[176:179]
    v_perm_b32 v8, v107, v99, s26
    v_perm_b32 v9, v123, v115, s26
    v_perm_b32 v10, v111, v103, s26
    v_perm_b32 v11, v127, v119, s26
    v_mfma_f32_16x16x32_bf16 v[180:183], v[4:7], v[12:15], v[180:183]
    v_perm_b32 v12, v107, v99, s27
    v_perm_b32 v13, v123, v115, s27
    v_perm_b32 v14, v111, v103, s27
    v_perm_b32 v15, v127, v119, s27
    v_mfma_f32_16x16x32_bf16 v[184:187], v[4:7], v[8:11], v[184:187]
    s_nop 0
    v_mfma_f32_16x16x32_bf16 v[188:191], v[4:7], v[12:15], v[188:191]
    s_cmp_le_u32 s38, 112
    s_cbranch_scc1 k2_sbb
    buffer_load_dwordx4 v[96:99], v16, s[4:7], 0 offen offset:256
    buffer_load_dwordx4 v[100:103], v17, s[4:7], 0 offen offset:256
    buffer_load_dwordx4 v[104:107], v18, s[4:7], 0 offen offset:256
    buffer_load_dwordx4 v[108:111], v19, s[4:7], 0 offen offset:256
    buffer_load_dwordx4 v[112:115], v20, s[4:7], 0 offen offset:256
    buffer_load_dwordx4 v[116:119], v21, s[4:7], 0 offen offset:256
    buffer_load_dwordx4 v[120:123], v22, s[4:7], 0 offen offset:256
    buffer_load_dwordx4 v[124:127], v23, s[4:7], 0 offen offset:256
    ds_read_b64_tr_b16 v[4:5], v2
    ds_read_b64_tr_b16 v[6:7], v3
    s_cmp_eq_u32 s25, 0
    s_cbranch_scc1 k2_stub0
k2_stub1:
    s_cmp_lt_u32 s20, s21
    s_cbranch_scc1 k2_oth1
    s_cmp_eq_u32 s40, 0
    s_cbranch_scc1 k2_sw0
k2_st1b:
    s_cmp_lt_u32 s22, s23
    s_cbranch_scc0 k2_tail1
    s_mov_b32 s24, s22
    s_sub_u32 s38, s23, s22
    s_add_u32 s22, s22, 128
    s_mov_b32 s25, 1
    s_branch k2_body1
k2_oth1:
    s_mov_b32 s24, s45
    s_add_u32 s45, s45, s46
    s_sub_u32 s38, s21, s20
    s_add_u32 s20, s20, 128
    s_mov_b32 s25, 0
k2_body1:
    v_add_u32_sdwa v2, s24, v1 dst_sel:DWORD dst_unused:UNUSED_PAD src0_sel:DWORD src1_sel:WORD_0
    v_and_or_b32 v8, v1, 12, s24
    ds_read2_b32 v[16:17], v8 offset0:0 offset1:4
    ds_read2_b32 v[18:19], v8 offset0:8 offset1:12
    ds_read2_b32 v[20:21], v8 offset0:16 offset1:20
    ds_read2_b32 v[22:23], v8 offset0:24 offset1:28
    ds_read2_b32 v[2:3], v2 offset0:0 offset1:4
    s_waitcnt vmcnt(8)
    v_perm_b32 v8, v72, v64, s26
    v_perm_b32 v9, v88, v80, s26
    v_perm_b32 v10, v76, v68, s26
    v_perm_b32 v11, v92, v84, s26
    v_perm_b32 v12, v72, v64, s27
    v_perm_b32 v13, v88, v80, s27
    v_perm_b32 v14, v76, v68, s27
    v_perm_b32 v15, v92, v84, s27
    s_waitcnt lgkmcnt(5)
    v_mfma_f32_16x16x32_bf16 v[192:195], v[4:7], v[8:11], v[192:195]
    v_perm_b32 v8, v73, v65, s26
    v_perm_b32 v9, v89, v81, s26
    v_perm_b32 v10, v77, v69, s26
    v_perm_b32 v11, v93, v85, s26
    v_mfma_f32_16x16x32_bf16 v[196:199], v[4:7], v[12:15], v[196:199]
    v_perm_b32 v12, v73, v65, s27
    v_perm_b32 v13, v89, v81, s27
    v_perm_b32 v14, v77, v69, s27
    v_perm_b32 v15, v93, v85, s27
    v_mfma_f32_16x16x32_bf16 v[200:203], v[4:7], v[8:11], v[200:203]
    v_perm_b32 v8, v74, v66, s26
    v_perm_b32 v9, v90, v82, s26
    v_perm_b32 v10, v78, v70, s26
    v_perm_b32 v11, v94, v86, s26
    v_mfma_f32_16x16x32_bf16 v[204:207], v[4:7], v[12:15], v[204:207]
    v_perm_b32 v12, v74, v66, s27
    v_perm_b32 v13, v90, v82, s27
    v_perm_b32 v14, v78, v70, s27
    v_perm_b32 v15, v94, v86, s27
    v_mfma_f32_16x16x32_bf16 v[208:211], v[4:7], v[8:11], v[208:211]
    v_perm_b32 v8, v75, v67, s26
    v_perm_b32 v9, v91, v83, s26
    v_perm_b32 v10, v79, v71, s26
    v_perm_b32 v11, v95, v87, s26
    v_mfma_f32_16x16x32_bf16 v[212:215], v[4:7], v[12:15], v[212:215]
    v_perm_b32 v12, v75, v67, s27
    v_perm_b32 v13, v91, v83, s27
    v_perm_b32 v14, v79, v71, s27
    v_perm_b32 v15, v95, v87, s27
    v_mfma_f32_16x16x32_bf16 v[216:219], v[4:7], v[8:11], v[216:219]
    s_nop 0
    v_mfma_f32_16x16x32_bf16 v[220:223], v[4:7], v[12:15], v[220:223]
    s_cmp_le_u32 s38, 112
    s_waitcnt lgkmcnt(0)
    s_cbranch_scc1 k2_sa1
    v_mad_u32_u16 v16, v16, s28, v0 op_sel:[1,0,0,0]
    buffer_load_dwordx4 v[64:67], v16, s[4:7], 0 offen
    v_mad_u32_u16 v17, v17, s28, v0 op_sel:[1,0,0,0]
    buffer_load_dwordx4 v[68:71], v17, s[4:7], 0 offen
    v_mad_u32_u16 v18, v18, s28, v0 op_sel:[1,0,0,0]
    buffer_load_dwordx4 v[72:75], v18, s[4:7], 0 offen
    v_mad_u32_u16 v19, v19, s28, v0 op_sel:[1,0,0,0]
    buffer_load_dwordx4 v[76:79], v19, s[4:7], 0 offen
    v_mad_u32_u16 v20, v20, s28, v0 op_sel:[1,0,0,0]
    buffer_load_dwordx4 v[80:83], v20, s[4:7], 0 offen
    v_mad_u32_u16 v21, v21, s28, v0 op_sel:[1,0,0,0]
    buffer_load_dwordx4 v[84:87], v21, s[4:7], 0 offen
    v_mad_u32_u16 v22, v22, s28, v0 op_sel:[1,0,0,0]
    buffer_load_dwordx4 v[88:91], v22, s[4:7], 0 offen
    v_mad_u32_u16 v23, v23, s28, v0 op_sel:[1,0,0,0]
    buffer_load_dwordx4 v[92:95], v23, s[4:7], 0 offen
k2_ra1:
    v_xor_b32_sdwa v2, v2, v1 dst_sel:DWORD dst_unused:UNUSED_PAD src0_sel:WORD_0 src1_sel:WORD_1
    v_xor_b32_sdwa v3, v3, v1 dst_sel:DWORD dst_unused:UNUSED_PAD src0_sel:WORD_0 src1_sel:WORD_1
    v_min_u32 v2, s29, v2
    v_min_u32 v3, s29, v3
    v_lshl_add_u32 v2, v2, 3, s30
    v_lshl_add_u32 v3, v3, 3, s30
    s_waitcnt vmcnt(8)
    v_perm_b32 v8, v104, v96, s26
    v_perm_b32 v9, v120, v112, s26
    v_perm_b32 v10, v108, v100, s26
    v_perm_b32 v11, v124, v116, s26
    v_perm_b32 v12, v104, v96, s27
    v_perm_b32 v13, v120, v112, s27
    v_perm_b32 v14, v108, v100, s27
    v_perm_b32 v15, v124, v116, s27
    v_mfma_f32_16x16x32_bf16 v[224:227], v[4:7], v[8:11], v[224:227]
    v_perm_b32 v8, v105, v97, s26
    v_perm_b32 v9, v121, v113, s26
    v_perm_b32 v10, v109, v101, s26
    v_perm_b32 v11, v125, v117, s26
    v_mfma_f32_16x16x32_bf16 v[228:231], v[4:7], v[12:15], v[228:231]
    v_perm_b32 v12, v105, v97, s27
    v_perm_b32 v13, v121, v113, s27
    v_perm_b32 v14, v109, v101, s27
    v_perm_b32 v15, v125, v117, s27
    v_mfma_f32_16x16x32_bf16 v[232:235], v[4:7], v[8:11], v[232:235]
    v_perm_b32 v8, v106, v98, s26
    v_perm_b32 v9, v122, v114, s26
    v_perm_b32 v10, v110, v102, s26
    v_perm_b32 v11, v126, v118, s26
    v_mfma_f32_16x16x32_bf16 v[236:239], v[4:7], v[12:15], v[236:239]
    v_perm_b32 v12, v106, v98, s27
    v_perm_b32 v13, v122, v114, s27
    v_perm_b32 v14, v110, v102, s27
    v_perm_b32 v15, v126, v118, s27
    v_mfma_f32_16x16x32_bf16 v[240:243], v[4:7], v[8:11], v[240:243]
    v_perm_b32 v8, v107, v99, s26
    v_perm_b32 v9, v123, v115, s26
    v_perm_b32 v10, v111, v103, s26
    v_perm_b32 v11, v127, v119, s26
    v_mfma_f32_16x16x32_bf16 v[244:247], v[4:7], v[12:15], v[244:247]
    v_perm_b32 v12, v107, v99, s27
    v_perm_b32 v13, v123, v115, s27
    v_perm_b32 v14, v111, v103, s27
    v_perm_b32 v15, v127, v119, s27
    v_mfma_f32_16x16x32_bf16 v[248:251], v[4:7], v[8:11], v[248:251]
    s_nop 0
    v_mfma_f32_16x16x32_bf16 v[252:255], v[4:7], v[12:15], v[252:255]
    s_cmp_le_u32 s38, 112
    s_cbranch_scc1 k2_sbb
    buffer_load_dwordx4 v[96:99], v16, s[4:7], 0 offen offset:256
    buffer_load_dwordx4 v[100:103], v17, s[4:7], 0 offen offset:256
    buffer_load_dwordx4 v[104:107], v18, s[4:7], 0 offen offset:256
    buffer_load_dwordx4 v[108:111], v19, s[4:7], 0 offen offset:256
    buffer_load_dwordx4 v[112:115], v20, s[4:7], 0 offen offset:256
    buffer_load_dwordx4 v[116:119], v21, s[4:7], 0 offen offset:256
    buffer_load_dwordx4 v[120:123], v22, s[4:7], 0 offen offset:256
    buffer_load_dwordx4 v[124:127], v23, s[4:7], 0 offen offset:256
    ds_read_b64_tr_b16 v[4:5], v2
    ds_read_b64_tr_b16 v[6:7], v3
    s_cmp_eq_u32 s25, 0
    s_cbranch_scc1 k2_stub0
    s_branch k2_stub1
k2_sa0:
    s_mov_b32 s39, 0
    s_branch k2_sa
k2_sa1:
    s_mov_b32 s39, 1
k2_sa:
    v_mad_u32_u16 v16, v16, s28, v0 op_sel:[1,0,0,0]
    s_cmp_le_u32 s38, 16
    buffer_load_dwordx4 v[64:67], v16, s[4:7], 0 offen
    s_cbranch_scc1 k2_x01
    v_mad_u32_u16 v17, v17, s28, v0 op_sel:[1,0,0,0]
    s_cmp_le_u32 s38, 32
    buffer_load_dwordx4 v[68:71], v17, s[4:7], 0 offen
    s_cbranch_scc1 k2_x02
    v_mad_u32_u16 v18, v18, s28, v0 op_sel:[1,0,0,0]
    s_cmp_le_u32 s38, 48
    buffer_load_dwordx4 v[72:75], v18, s[4:7], 0 offen
    s_cbranch_scc1 k2_x03
    v_mad_u32_u16 v19, v19, s28, v0 op_sel:[1,0,0,0]
    s_cmp_le_u32 s38, 64
    buffer_load_dwordx4 v[76:79], v19, s[4:7], 0 offen
    s_cbranch_scc1 k2_x04
    v_mad_u32_u16 v20, v20, s28, v0 op_sel:[1,0,0,0]
    s_cmp_le_u32 s38, 80
    buffer_load_dwordx4 v[80:83], v20, s[4:7], 0 offen
    s_cbranch_scc1 k2_x05
    v_mad_u32_u16 v21, v21, s28, v0 op_sel:[1,0,0,0]
    s_cmp_le_u32 s38, 96
    buffer_load_dwordx4 v[84:87], v21, s[4:7], 0 offen
    s_cbranch_scc1 k2_x06
    v_mad_u32_u16 v22, v22, s28, v0 op_sel:[1,0,0,0]
    buffer_load_dwordx4 v[88:91], v22, s[4:7], 0 offen
    s_branch k2_x07
k2_x01:
    s_waitcnt vmcnt(1)
k2_x02:
    s_waitcnt vmcnt(2)
k2_x03:
    s_waitcnt vmcnt(3)
k2_x04:
    s_waitcnt vmcnt(4)
k2_x05:
    s_waitcnt vmcnt(5)
k2_x06:
    s_waitcnt vmcnt(6)
k2_x07:
    s_waitcnt vmcnt(7)
    s_cmp_eq_u32 s39, 0
    s_cbranch_scc1 k2_ra0
    s_branch k2_ra1
k2_sbb:
    s_cmp_le_u32 s38, 16
    buffer_load_dwordx4 v[96:99], v16, s[4:7], 0 offen offset:256
    ds_read_b64_tr_b16 v[4:5], v2
    ds_read_b64_tr_b16 v[6:7], v3
    s_cbranch_scc1 k2_x11
    s_cmp_le_u32 s38, 32
    buffer_load_dwordx4 v[100:103], v17, s[4:7], 0 offen offset:256
    s_cbranch_scc1 k2_x12
    s_cmp_le_u32 s38, 48
    buffer_load_dwordx4 v[104:107], v18, s[4:7], 0 offen offset:256
    s_cbranch_scc1 k2_x13
    s_cmp_le_u32 s38, 64
    buffer_load_dwordx4 v[108:111], v19, s[4:7], 0 offen offset:256
    s_cbranch_scc1 k2_x14
    s_cmp_le_u32 s38, 80
    buffer_load_dwordx4 v[112:115], v20, s[4:7], 0 offen offset:256
    s_cbranch_scc1 k2_x15
    s_cmp_le_u32 s38, 96
    buffer_load_dwordx4 v[116:119], v21, s[4:7], 0 offen offset:256
    s_cbranch_scc1 k2_x16
    buffer_load_dwordx4 v[120:123], v22, s[4:7], 0 offen offset:256
    s_branch k2_x17
k2_x11:
    s_waitcnt vmcnt(1)
k2_x12:
    s_waitcnt vmcnt(2)
k2_x13:
    s_waitcnt vmcnt(3)
k2_x14:
    s_waitcnt vmcnt(4)
k2_x15:
    s_waitcnt vmcnt(5)
k2_x16:
    s_waitcnt vmcnt(6)
k2_x17:
    s_waitcnt vmcnt(7)
    s_cmp_eq_u32 s25, 0
    s_cbranch_scc1 k2_stub0
    s_branch k2_stub1
k2_tail0:
    s_waitcnt vmcnt(8)
    v_perm_b32 v8, v72, v64, s26
    v_perm_b32 v9, v88, v80, s26
    v_perm_b32 v10, v76, v68, s26
    v_perm_b32 v11, v92, v84, s26
    v_perm_b32 v12, v72, v64, s27
    v_perm_b32 v13, v88, v80, s27
    v_perm_b32 v14, v76, v68, s27
    v_perm_b32 v15, v92, v84, s27
    s_waitcnt lgkmcnt(0)
    v_mfma_f32_16x16x32_bf16 v[128:131], v[4:7], v[8:11], v[128:131]
    v_perm_b32 v8, v73, v65, s26
    v_perm_b32 v9, v89, v81, s26
    v_perm_b32 v10, v77, v69, s26
    v_perm_b32 v11, v93, v85, s26
    v_mfma_f32_16x16x32_bf16 v[132:135], v[4:7], v[12:15], v[132:135]
    v_perm_b32 v12, v73, v65, s27
    v_perm_b32 v13, v89, v81, s27
    v_perm_b32 v14, v77, v69, s27
    v_perm_b32 v15, v93, v85, s27
    v_mfma_f32_16x16x32_bf16 v[136:139], v[4:7], v[8:11], v[136:139]
    v_perm_b32 v8, v74, v66, s26
    v_perm_b32 v9, v90, v82, s26
    v_perm_b32 v10, v78, v70, s26
    v_perm_b32 v11, v94, v86, s26
    v_mfma_f32_16x16x32_bf16 v[140:143], v[4:7], v[12:15], v[140:143]
    v_perm_b32 v12, v74, v66, s27
    v_perm_b32 v13, v90, v82, s27
    v_perm_b32 v14, v78, v70, s27
    v_perm_b32 v15, v94, v86, s27
    v_mfma_f32_16x16x32_bf16 v[144:147], v[4:7], v[8:11], v[144:147]
    v_perm_b32 v8, v75, v67, s26
    v_perm_b32 v9, v91, v83, s26
    v_perm_b32 v10, v79, v71, s26
    v_perm_b32 v11, v95, v87, s26
    v_mfma_f32_16x16x32_bf16 v[148:151], v[4:7], v[12:15], v[148:151]
    v_perm_b32 v12, v75, v67, s27
    v_perm_b32 v13, v91, v83, s27
    v_perm_b32 v14, v79, v71, s27
    v_perm_b32 v15, v95, v87, s27
    v_mfma_f32_16x16x32_bf16 v[152:155], v[4:7], v[8:11], v[152:155]
    s_nop 0
    v_mfma_f32_16x16x32_bf16 v[156:159], v[4:7], v[12:15], v[156:159]
    s_waitcnt vmcnt(0)
    v_perm_b32 v8, v104, v96, s26
    v_perm_b32 v9, v120, v112, s26
    v_perm_b32 v10, v108, v100, s26
    v_perm_b32 v11, v124, v116, s26
    v_perm_b32 v12, v104, v96, s27
    v_perm_b32 v13, v120, v112, s27
    v_perm_b32 v14, v108, v100, s27
    v_perm_b32 v15, v124, v116, s27
    v_mfma_f32_16x16x32_bf16 v[160:163], v[4:7], v[8:11], v[160:163]
    v_perm_b32 v8, v105, v97, s26
    v_perm_b32 v9, v121, v113, s26
    v_perm_b32 v10, v109, v101, s26
    v_perm_b32 v11, v125, v117, s26
    v_mfma_f32_16x16x32_bf16 v[164:167], v[4:7], v[12:15], v[164:167]
    v_perm_b32 v12, v105, v97, s27
    v_perm_b32 v13, v121, v113, s27
    v_perm_b32 v14, v109, v101, s27
    v_perm_b32 v15, v125, v117, s27
    v_mfma_f32_16x16x32_bf16 v[168:171], v[4:7], v[8:11], v[168:171]
    v_perm_b32 v8, v106, v98, s26
    v_perm_b32 v9, v122, v114, s26
    v_perm_b32 v10, v110, v102, s26
    v_perm_b32 v11, v126, v118, s26
    v_mfma_f32_16x16x32_bf16 v[172:175], v[4:7], v[12:15], v[172:175]
    v_perm_b32 v12, v106, v98, s27
    v_perm_b32 v13, v122, v114, s27
    v_perm_b32 v14, v110, v102, s27
    v_perm_b32 v15, v126, v118, s27
    v_mfma_f32_16x16x32_bf16 v[176:179], v[4:7], v[8:11], v[176:179]
    v_perm_b32 v8, v107, v99, s26
    v_perm_b32 v9, v123, v115, s26
    v_perm_b32 v10, v111, v103, s26
    v_perm_b32 v11, v127, v119, s26
    v_mfma_f32_16x16x32_bf16 v[180:183], v[4:7], v[12:15], v[180:183]
    v_perm_b32 v12, v107, v99, s27
    v_perm_b32 v13, v123, v115, s27
    v_perm_b32 v14, v111, v103, s27
    v_perm_b32 v15, v127, v119, s27
    v_mfma_f32_16x16x32_bf16 v[184:187], v[4:7], v[8:11], v[184:187]
    s_nop 0
    v_mfma_f32_16x16x32_bf16 v[188:191], v[4:7], v[12:15], v[188:191]
    s_branch k2_done
k2_tail1:
    s_waitcnt vmcnt(8)
    v_perm_b32 v8, v72, v64, s26
    v_perm_b32 v9, v88, v80, s26
    v_perm_b32 v10, v76, v68, s26
    v_perm_b32 v11, v92, v84, s26
    v_perm_b32 v12, v72, v64, s27
    v_perm_b32 v13, v88, v80, s27
    v_perm_b32 v14, v76, v68, s27
    v_perm_b32 v15, v92, v84, s27
    s_waitcnt lgkmcnt(0)
    v_mfma_f32_16x16x32_bf16 v[192:195], v[4:7], v[8:11], v[192:195]
    v_perm_b32 v8, v73, v65, s26
    v_perm_b32 v9, v89, v81, s26
    v_perm_b32 v10, v77, v69, s26
    v_perm_b32 v11, v93, v85, s26
    v_mfma_f32_16x16x32_bf16 v[196:199], v[4:7], v[12:15], v[196:199]
    v_perm_b32 v12, v73, v65, s27
    v_perm_b32 v13, v89, v81, s27
    v_perm_b32 v14, v77, v69, s27
    v_perm_b32 v15, v93, v85, s27
    v_mfma_f32_16x16x32_bf16 v[200:203], v[4:7], v[8:11], v[200:203]
    v_perm_b32 v8, v74, v66, s26
    v_perm_b32 v9, v90, v82, s26
    v_perm_b32 v10, v78, v70, s26
    v_perm_b32 v11, v94, v86, s26
    v_mfma_f32_16x16x32_bf16 v[204:207], v[4:7], v[12:15], v[204:207]
    v_perm_b32 v12, v74, v66, s27
    v_perm_b32 v13, v90, v82, s27
    v_perm_b32 v14, v78, v70, s27
    v_perm_b32 v15, v94, v86, s27
    v_mfma_f32_16x16x32_bf16 v[208:211], v[4:7], v[8:11], v[208:211]
    v_perm_b32 v8, v75, v67, s26
    v_perm_b32 v9, v91, v83, s26
    v_perm_b32 v10, v79, v71, s26
    v_perm_b32 v11, v95, v87, s26
    v_mfma_f32_16x16x32_bf16 v[212:215], v[4:7], v[12:15], v[212:215]
    v_perm_b32 v12, v75, v67, s27
    v_perm_b32 v13, v91, v83, s27
    v_perm_b32 v14, v79, v71, s27
    v_perm_b32 v15, v95, v87, s27
    v_mfma_f32_16x16x32_bf16 v[216:219], v[4:7], v[8:11], v[216:219]
    s_nop 0
    v_mfma_f32_16x16x32_bf16 v[220:223], v[4:7], v[12:15], v[220:223]
    s_waitcnt vmcnt(0)
    v_perm_b32 v8, v104, v96, s26
    v_perm_b32 v9, v120, v112, s26
    v_perm_b32 v10, v108, v100, s26
    v_perm_b32 v11, v124, v116, s26
    v_perm_b32 v12, v104, v96, s27
    v_perm_b32 v13, v120, v112, s27
    v_perm_b32 v14, v108, v100, s27
    v_perm_b32 v15, v124, v116, s27
    v_mfma_f32_16x16x32_bf16 v[224:227], v[4:7], v[8:11], v[224:227]
    v_perm_b32 v8, v105, v97, s26
    v_perm_b32 v9, v121, v113, s26
    v_perm_b32 v10, v109, v101, s26
    v_perm_b32 v11, v125, v117, s26
    v_mfma_f32_16x16x32_bf16 v[228:231], v[4:7], v[12:15], v[228:231]
    v_perm_b32 v12, v105, v97, s27
    v_perm_b32 v13, v121, v113, s27
    v_perm_b32 v14, v109, v101, s27
    v_perm_b32 v15, v125, v117, s27
    v_mfma_f32_16x16x32_bf16 v[232:235], v[4:7], v[8:11], v[232:235]
    v_perm_b32 v8, v106, v98, s26
    v_perm_b32 v9, v122, v114, s26
    v_perm_b32 v10, v110, v102, s26
    v_perm_b32 v11, v126, v118, s26
    v_mfma_f32_16x16x32_bf16 v[236:239], v[4:7], v[12:15], v[236:239]
    v_perm_b32 v12, v106, v98, s27
    v_perm_b32 v13, v122, v114, s27
    v_perm_b32 v14, v110, v102, s27
    v_perm_b32 v15, v126, v118, s27
    v_mfma_f32_16x16x32_bf16 v[240:243], v[4:7], v[8:11], v[240:243]
    v_perm_b32 v8, v107, v99, s26
    v_perm_b32 v9, v123, v115, s26
    v_perm_b32 v10, v111, v103, s26
    v_perm_b32 v11, v127, v119, s26
    v_mfma_f32_16x16x32_bf16 v[244:247], v[4:7], v[12:15], v[244:247]
    v_perm_b32 v12, v107, v99, s27
    v_perm_b32 v13, v123, v115, s27
    v_perm_b32 v14, v111, v103, s27
    v_perm_b32 v15, v127, v119, s27
    v_mfma_f32_16x16x32_bf16 v[248:251], v[4:7], v[8:11], v[248:251]
    s_nop 0
    v_mfma_f32_16x16x32_bf16 v[252:255], v[4:7], v[12:15], v[252:255]
k2_done:
    s_waitcnt vmcnt(0)
    s_cmp_eq_u32 s18, 0
    s_cbranch_scc1 k2_fin
    s_add_u32 s17, s17, 8192
    s_movk_i32 s3, 255
    s_barrier
    s_branch k2_round
k2_p1h:
    v_readfirstlane_b32 s3, v21
    s_sub_u32 s3, s3, 1
    s_add_u32 s36, s36, 1
    s_cmp_gt_u32 s36, 2000
    s_cbranch_scc1 k2_end
    s_waitcnt vmcnt(0) lgkmcnt(0)
    s_barrier
    s_branch k2_round
k2_np:
    ds_read_b32 v8, v12 offset:3088
    s_waitcnt lgkmcnt(0)
    v_readfirstlane_b32 s87, v8
    s_branch k2_b3b
k2_hpub:
    s_bitcmp1_b32 s2, 1
    s_cselect_b64 vcc, -1, 0
    s_lshl_b32 s33, s2, 4
    s_lshr_b32 s34, s2, 2
    s_lshl_b32 s32, s3, 2
    s_add_u32 s32, s32, 96576
    v_cndmask_b32 v76, v76, v77, vcc
    v_cndmask_b32 v77, v77, v78, vcc
    v_mov_b32 v4, s32
    v_alignbit_b32 v76, v77, v76, s33
    v_or_b32 v76, 3, v76
    s_lshl_b64 exec, 1, s34
    ds_write_b32 v4, v76
    s_mov_b64 exec, -1
    v_add_u32 v7, -63136, v18
    ds_read2st64_b32 v[80:81], v7 offset0:0 offset1:1
    ds_read2st64_b32 v[82:83], v7 offset0:2 offset1:3
    s_branch k2_w7p
k2_hst:
    v_mov_b32 v5, s2
    v_lshlrev_b32 v5, 2, v5
    ds_read_b32 v4, v5 offset:1024
    ds_read_b32 v6, v5 offset:2048
    s_waitcnt lgkmcnt(0)
    v_sub_u32 v6, v8, v6
    s_mov_b64 exec, -1
    v_cmp_lt_u32 vcc, v6, v4
    v_add_u32 v6, 1024, v6
    s_mov_b64 exec, vcc
    buffer_store_dwordx4 v[192:195], v8, s[8:11], s32 offen offset:0 sc1
    s_mov_b64 exec, -1
    v_cmp_lt_u32 vcc, v6, v4
    v_add_u32 v6, 1024, v6
    s_mov_b64 exec, vcc
    buffer_store_dwordx4 v[196:199], v8, s[8:11], s32 offen offset:1024 sc1
    s_mov_b64 exec, -1
    v_cmp_lt_u32 vcc, v6, v4
    v_add_u32 v6, 1024, v6
    s_mov_b64 exec, vcc
    buffer_store_dwordx4 v[200:203], v8, s[8:11], s32 offen offset:2048 sc1
    s_mov_b64 exec, -1
    v_cmp_lt_u32 vcc, v6, v4
    v_add_u32 v6, 1024, v6
    s_mov_b64 exec, vcc
    buffer_store_dwordx4 v[204:207], v8, s[8:11], s32 offen offset:3072 sc1
    s_mov_b64 exec, -1
    v_cmp_lt_u32 vcc, v6, v4
    v_add_u32 v6, 1024, v6
    s_mov_b64 exec, vcc
    buffer_store_dwordx4 v[208:211], v8, s[8:11], s33 offen offset:0 sc1
    s_mov_b64 exec, -1
    v_cmp_lt_u32 vcc, v6, v4
    v_add_u32 v6, 1024, v6
    s_mov_b64 exec, vcc
    buffer_store_dwordx4 v[212:215], v8, s[8:11], s33 offen offset:1024 sc1
    s_mov_b64 exec, -1
    v_cmp_lt_u32 vcc, v6, v4
    v_add_u32 v6, 1024, v6
    s_mov_b64 exec, vcc
    buffer_store_dwordx4 v[216:219], v8, s[8:11], s33 offen offset:2048 sc1
    s_mov_b64 exec, -1
    v_cmp_lt_u32 vcc, v6, v4
    v_add_u32 v6, 1024, v6
    s_mov_b64 exec, vcc
    buffer_store_dwordx4 v[220:223], v8, s[8:11], s33 offen offset:3072 sc1
    s_waitcnt vmcnt(0)
    s_branch k2_b3b
k2_fin:
    s_xor_b32 s37, s16, 7
    s_or_b32 s37, s37, s36
    s_cbranch_scc1 k2_ne
    buffer_load_dword v127, off, s[8:11], 0 sc1
k2_ne:
    s_setprio 0
    s_cmp_lg_u32 s40, 0
    s_cbranch_scc1 k2_sw1
    s_mov_b32 s40, 1
k2_sw0:
    v_mbcnt_lo_u32_b32 v2, -1, 0
    v_mbcnt_hi_u32_b32 v2, -1, v2
    s_and_b32 s32, s16, 3
    s_lshr_b32 s33, s16, 2
    s_mul_i32 s34, s33, 28
    s_add_u32 s34, s32, s34
    v_lshrrev_b32 v3, 4, v2
    v_lshl_add_u32 v3, v3, 2, s34
    v_mul_u32_u24 v3, 1440, v3
    v_bfe_u32 v9, v2, 3, 1
    v_mul_u32_u24 v9, 640, v9
    v_and_b32 v10, 7, v2
    v_lshl_add_u32 v9, v10, 4, v9
    v_add_u32 v3, v3, v9
    s_cmp_lg_u32 s33, 0
    s_cselect_b32 s33, -1, 0xffff
    s_cselect_b32 s34, 1, 0x10000
    v_add_f32_dpp v129, v163, v129 quad_perm:[0,1,2,3] row_mask:0xf bank_mask:0xc
    v_sub_f32_dpp v130, v161, v130 row_shr:8 row_mask:0xf bank_mask:0xc
    v_subrev_f32_dpp v131, v161, v131 quad_perm:[0,1,2,3] row_mask:0xf bank_mask:0xc
    v_add_f32_dpp v129, v162, v129 row_shr:8 row_mask:0xf bank_mask:0xc
    v_subrev_f32_dpp v162, v163, v162 row_shr:8 row_mask:0xf bank_mask:0xc
    v_add_f32_dpp v133, v167, v133 quad_perm:[0,1,2,3] row_mask:0xf bank_mask:0xc
    v_sub_f32_dpp v134, v165, v134 row_shr:8 row_mask:0xf bank_mask:0xc
    v_subrev_f32_dpp v135, v165, v135 quad_perm:[0,1,2,3] row_mask:0xf bank_mask:0xc
    v_add_f32_dpp v133, v166, v133 row_shr:8 row_mask:0xf bank_mask:0xc
    v_subrev_f32_dpp v166, v167, v166 row_shr:8 row_mask:0xf bank_mask:0xc
    v_add_f32_dpp v137, v171, v137 quad_perm:[0,1,2,3] row_mask:0xf bank_mask:0xc
    v_sub_f32_dpp v138, v169, v138 row_shr:8 row_mask:0xf bank_mask:0xc
    v_subrev_f32_dpp v139, v169, v139 quad_perm:[0,1,2,3] row_mask:0xf bank_mask:0xc
    v_add_f32_dpp v137, v170, v137 row_shr:8 row_mask:0xf bank_mask:0xc
    v_subrev_f32_dpp v170, v171, v170 row_shr:8 row_mask:0xf bank_mask:0xc
    v_add_f32_dpp v141, v175, v141 quad_perm:[0,1,2,3] row_mask:0xf bank_mask:0xc
    v_sub_f32_dpp v142, v173, v142 row_shr:8 row_mask:0xf bank_mask:0xc
    v_subrev_f32_dpp v143, v173, v143 quad_perm:[0,1,2,3] row_mask:0xf bank_mask:0xc
    v_add_f32_dpp v141, v174, v141 row_shr:8 row_mask:0xf bank_mask:0xc
    v_subrev_f32_dpp v174, v175, v174 row_shr:8 row_mask:0xf bank_mask:0xc
    v_add_f32_dpp v145, v179, v145 quad_perm:[0,1,2,3] row_mask:0xf bank_mask:0xc
    v_sub_f32_dpp v146, v177, v146 row_shr:8 row_mask:0xf bank_mask:0xc
    v_subrev_f32_dpp v147, v177, v147 quad_perm:[0,1,2,3] row_mask:0xf bank_mask:0xc
    v_add_f32_dpp v145, v178, v145 row_shr:8 row_mask:0xf bank_mask:0xc
    v_subrev_f32_dpp v178, v179, v178 row_shr:8 row_mask:0xf bank_mask:0xc
    v_add_f32_dpp v149, v183, v149 quad_perm:[0,1,2,3] row_mask:0xf bank_mask:0xc
    v_sub_f32_dpp v150, v181, v150 row_shr:8 row_mask:0xf bank_mask:0xc
    v_subrev_f32_dpp v151, v181, v151 quad_perm:[0,1,2,3] row_mask:0xf bank_mask:0xc
    v_add_f32_dpp v149, v182, v149 row_shr:8 row_mask:0xf bank_mask:0xc
    v_subrev_f32_dpp v182, v183, v182 row_shr:8 row_mask:0xf bank_mask:0xc
    v_add_f32_dpp v153, v187, v153 quad_perm:[0,1,2,3] row_mask:0xf bank_mask:0xc
    v_sub_f32_dpp v154, v185, v154 row_shr:8 row_mask:0xf bank_mask:0xc
    v_subrev_f32_dpp v155, v185, v155 quad_perm:[0,1,2,3] row_mask:0xf bank_mask:0xc
    v_add_f32_dpp v153, v186, v153 row_shr:8 row_mask:0xf bank_mask:0xc
    v_subrev_f32_dpp v186, v187, v186 row_shr:8 row_mask:0xf bank_mask:0xc
    v_add_f32_dpp v157, v191, v157 quad_perm:[0,1,2,3] row_mask:0xf bank_mask:0xc
    v_sub_f32_dpp v158, v189, v158 row_shr:8 row_mask:0xf bank_mask:0xc
    v_subrev_f32_dpp v159, v189, v159 quad_perm:[0,1,2,3] row_mask:0xf bank_mask:0xc
    v_add_f32_dpp v157, v190, v157 row_shr:8 row_mask:0xf bank_mask:0xc
    v_subrev_f32_dpp v190, v191, v190 row_shr:8 row_mask:0xf bank_mask:0xc
    s_mov_b32 exec_hi, s33
    v_cvt_pk_bf16_f32 v8, v128, v132
    v_cvt_pk_bf16_f32 v9, v136, v140
    v_cvt_pk_bf16_f32 v10, v144, v148
    v_cvt_pk_bf16_f32 v11, v152, v156
    ds_write_b128 v3, v[8:11] offset:0
    v_cvt_pk_bf16_f32 v12, v129, v133
    v_cvt_pk_bf16_f32 v13, v137, v141
    v_cvt_pk_bf16_f32 v14, v145, v149
    v_cvt_pk_bf16_f32 v15, v153, v157
    ds_write_b128 v3, v[12:15] offset:128
    v_cvt_pk_bf16_f32 v16, v130, v134
    v_cvt_pk_bf16_f32 v17, v138, v142
    v_cvt_pk_bf16_f32 v18, v146, v150
    v_cvt_pk_bf16_f32 v19, v154, v158
    ds_write_b128 v3, v[16:19] offset:256
    v_cvt_pk_bf16_f32 v20, v131, v135
    v_cvt_pk_bf16_f32 v21, v139, v143
    v_cvt_pk_bf16_f32 v22, v147, v151
    v_cvt_pk_bf16_f32 v23, v155, v159
    ds_write_b128 v3, v[20:23] offset:384
    v_cvt_pk_bf16_f32 v128, v160, v164
    v_cvt_pk_bf16_f32 v129, v168, v172
    v_cvt_pk_bf16_f32 v130, v176, v180
    v_cvt_pk_bf16_f32 v131, v184, v188
    ds_write_b128 v3, v[128:131] offset:512
    v_cvt_pk_bf16_f32 v132, v162, v166
    v_cvt_pk_bf16_f32 v133, v170, v174
    v_cvt_pk_bf16_f32 v134, v178, v182
    v_cvt_pk_bf16_f32 v135, v186, v190
    s_mov_b32 exec_lo, 0xff00ff00
    s_and_b32 exec_hi, exec_hi, 0xff00ff00
    ds_write_b128 v3, v[132:135] offset:640
    s_mov_b64 exec, -1
    v_mov_b32 v149, 163816
    v_mov_b32 v144, s34
    s_mov_b64 exec, 1
    ds_add_u32 v149, v144
    s_mov_b64 exec, -1
    v_mov_b32 v144, v3
    v_lshrrev_b32 v3, 4, v2
    v_and_b32 v150, 15, v2
    v_mul_u32_u24 v145, 1440, v150
    v_lshl_add_u32 v145, v3, 4, v145
    s_lshl_b32 s32, s32, 5
    v_mul_u32_u24 v146, 528, v150
    v_lshl_add_u32 v3, v3, 3, s32
    v_add_u32 v146, v146, v3
    v_lshrrev_b32 v148, 5, v2
    v_and_b32 v147, 31, v2
    v_lshlrev_b32 v147, 4, v147
    s_lshl_b32 s32, s16, 1
    v_add_u32 v2, s32, v148
    v_mul_u32_u24 v150, 528, v2
    v_add_u32 v150, v150, v147
    v_add_u32 v150, 100176, v150
    v_and_b32 v3, 12, v2
    v_add_u32 v2, v2, v3
    v_lshl_or_b32 v2, v2, 1, 1
    s_lshl_b32 s32, s2, 9
    v_lshl_add_u32 v151, v2, 17, s32
    s_add_u32 s40, s40, 1
    s_cmp_eq_u32 s40, 1
    s_cbranch_scc1 k2_st1b
k2_sw1:
    v_add_f32_dpp v193, v227, v193 quad_perm:[0,1,2,3] row_mask:0xf bank_mask:0xc
    v_sub_f32_dpp v194, v225, v194 row_shr:8 row_mask:0xf bank_mask:0xc
    v_subrev_f32_dpp v195, v225, v195 quad_perm:[0,1,2,3] row_mask:0xf bank_mask:0xc
    v_add_f32_dpp v193, v226, v193 row_shr:8 row_mask:0xf bank_mask:0xc
    v_subrev_f32_dpp v226, v227, v226 row_shr:8 row_mask:0xf bank_mask:0xc
    v_add_f32_dpp v197, v231, v197 quad_perm:[0,1,2,3] row_mask:0xf bank_mask:0xc
    v_sub_f32_dpp v198, v229, v198 row_shr:8 row_mask:0xf bank_mask:0xc
    v_subrev_f32_dpp v199, v229, v199 quad_perm:[0,1,2,3] row_mask:0xf bank_mask:0xc
    v_add_f32_dpp v197, v230, v197 row_shr:8 row_mask:0xf bank_mask:0xc
    v_subrev_f32_dpp v230, v231, v230 row_shr:8 row_mask:0xf bank_mask:0xc
    v_add_f32_dpp v201, v235, v201 quad_perm:[0,1,2,3] row_mask:0xf bank_mask:0xc
    v_sub_f32_dpp v202, v233, v202 row_shr:8 row_mask:0xf bank_mask:0xc
    v_subrev_f32_dpp v203, v233, v203 quad_perm:[0,1,2,3] row_mask:0xf bank_mask:0xc
    v_add_f32_dpp v201, v234, v201 row_shr:8 row_mask:0xf bank_mask:0xc
    v_subrev_f32_dpp v234, v235, v234 row_shr:8 row_mask:0xf bank_mask:0xc
    v_add_f32_dpp v205, v239, v205 quad_perm:[0,1,2,3] row_mask:0xf bank_mask:0xc
    v_sub_f32_dpp v206, v237, v206 row_shr:8 row_mask:0xf bank_mask:0xc
    v_subrev_f32_dpp v207, v237, v207 quad_perm:[0,1,2,3] row_mask:0xf bank_mask:0xc
    v_add_f32_dpp v205, v238, v205 row_shr:8 row_mask:0xf bank_mask:0xc
    v_subrev_f32_dpp v238, v239, v238 row_shr:8 row_mask:0xf bank_mask:0xc
    v_add_f32_dpp v209, v243, v209 quad_perm:[0,1,2,3] row_mask:0xf bank_mask:0xc
    v_sub_f32_dpp v210, v241, v210 row_shr:8 row_mask:0xf bank_mask:0xc
    v_subrev_f32_dpp v211, v241, v211 quad_perm:[0,1,2,3] row_mask:0xf bank_mask:0xc
    v_add_f32_dpp v209, v242, v209 row_shr:8 row_mask:0xf bank_mask:0xc
    v_subrev_f32_dpp v242, v243, v242 row_shr:8 row_mask:0xf bank_mask:0xc
    v_add_f32_dpp v213, v247, v213 quad_perm:[0,1,2,3] row_mask:0xf bank_mask:0xc
    v_sub_f32_dpp v214, v245, v214 row_shr:8 row_mask:0xf bank_mask:0xc
    v_subrev_f32_dpp v215, v245, v215 quad_perm:[0,1,2,3] row_mask:0xf bank_mask:0xc
    v_add_f32_dpp v213, v246, v213 row_shr:8 row_mask:0xf bank_mask:0xc
    v_subrev_f32_dpp v246, v247, v246 row_shr:8 row_mask:0xf bank_mask:0xc
    v_add_f32_dpp v217, v251, v217 quad_perm:[0,1,2,3] row_mask:0xf bank_mask:0xc
    v_sub_f32_dpp v218, v249, v218 row_shr:8 row_mask:0xf bank_mask:0xc
    v_subrev_f32_dpp v219, v249, v219 quad_perm:[0,1,2,3] row_mask:0xf bank_mask:0xc
    v_add_f32_dpp v217, v250, v217 row_shr:8 row_mask:0xf bank_mask:0xc
    v_subrev_f32_dpp v250, v251, v250 row_shr:8 row_mask:0xf bank_mask:0xc
    v_add_f32_dpp v221, v255, v221 quad_perm:[0,1,2,3] row_mask:0xf bank_mask:0xc
    v_sub_f32_dpp v222, v253, v222 row_shr:8 row_mask:0xf bank_mask:0xc
    v_subrev_f32_dpp v223, v253, v223 quad_perm:[0,1,2,3] row_mask:0xf bank_mask:0xc
    v_add_f32_dpp v221, v254, v221 row_shr:8 row_mask:0xf bank_mask:0xc
    v_subrev_f32_dpp v254, v255, v254 row_shr:8 row_mask:0xf bank_mask:0xc
    s_mov_b32 exec_hi, 0xffff
    v_cvt_pk_bf16_f32 v64, v192, v196
    v_cvt_pk_bf16_f32 v65, v200, v204
    v_cvt_pk_bf16_f32 v66, v208, v212
    v_cvt_pk_bf16_f32 v67, v216, v220
    ds_write_b128 v144, v[64:67] offset:23040
    v_cvt_pk_bf16_f32 v68, v193, v197
    v_cvt_pk_bf16_f32 v69, v201, v205
    v_cvt_pk_bf16_f32 v70, v209, v213
    v_cvt_pk_bf16_f32 v71, v217, v221
    ds_write_b128 v144, v[68:71] offset:23168
    v_cvt_pk_bf16_f32 v72, v194, v198
    v_cvt_pk_bf16_f32 v73, v202, v206
    v_cvt_pk_bf16_f32 v74, v210, v214
    v_cvt_pk_bf16_f32 v75, v218, v222
    ds_write_b128 v144, v[72:75] offset:23296
    v_cvt_pk_bf16_f32 v76, v195, v199
    v_cvt_pk_bf16_f32 v77, v203, v207
    v_cvt_pk_bf16_f32 v78, v211, v215
    v_cvt_pk_bf16_f32 v79, v219, v223
    ds_write_b128 v144, v[76:79] offset:23424
    v_cvt_pk_bf16_f32 v80, v224, v228
    v_cvt_pk_bf16_f32 v81, v232, v236
    v_cvt_pk_bf16_f32 v82, v240, v244
    v_cvt_pk_bf16_f32 v83, v248, v252
    ds_write_b128 v144, v[80:83] offset:23552
    v_cvt_pk_bf16_f32 v84, v226, v230
    v_cvt_pk_bf16_f32 v85, v234, v238
    v_cvt_pk_bf16_f32 v86, v242, v246
    v_cvt_pk_bf16_f32 v87, v250, v254
    s_mov_b32 exec_lo, 0xff00ff00
    s_and_b32 exec_hi, exec_hi, 0xff00ff00
    ds_write_b128 v144, v[84:87] offset:23680
    s_cmp_lt_u32 s16, 4
    s_cbranch_scc1 k2_lsb
    s_mov_b64 exec, -1
    v_mov_b32 v13, 0x100
    s_mov_b32 s33, 0xbfb8aa3b
    s_mov_b32 s20, 0x1fff1fff
    s_mov_b32 s21, 0x1fff1fff
    v_add_u32 v4, 40320, v145
    v_add_u32 v5, 93312, v146
    s_mov_b32 s25, 0
    s_mov_b64 exec, 1
    ds_add_u32 v149, v13
k2_hsp:
    ds_read_u8 v13, v149
    s_waitcnt lgkmcnt(0)
    v_cmp_gt_u32 vcc, 4, v13
    s_cbranch_vccz k2_hgo
    s_sleep 2
    s_branch k2_hsp
k2_lsb:
    s_mov_b64 exec, -1
    s_waitcnt lgkmcnt(0)
    s_barrier
    v_mad_u32_u24 v8, v148, 20, s16
    v_mul_u32_u24 v8, 528, v8
    v_add_u32 v8, v8, v147
    v_add_u32 v8, 80640, v8
    ds_read_b128 v[64:67], v8 offset:0
    ds_read_b128 v[68:71], v8 offset:2112
    ds_read_b128 v[72:75], v8 offset:4224
    ds_read_b128 v[76:79], v8 offset:6336
    ds_read_b128 v[80:83], v8 offset:8448
    s_lshl_b32 s32, s2, 9
    s_lshl_b32 s33, s16, 18
    s_add_u32 s32, s32, s33
    v_add_u32 v9, s32, v147
    v_mad_i32_i24 v10, v148, 41, 0
    v_lshl_add_u32 v10, v10, 17, v9
    v_mad_i32_i24 v11, v148, -8, 16
    v_lshl_add_u32 v11, v11, 17, v9
    v_mad_i32_i24 v12, v148, -8, 32
    v_lshl_add_u32 v12, v12, 17, v9
    v_mad_i32_i24 v13, v148, 31, 9
    v_lshl_add_u32 v13, v13, 17, v9
    v_mad_i32_i24 v14, v148, 23, 25
    v_lshl_add_u32 v14, v14, 17, v9
    s_cmp_eq_u32 s16, 0
    s_waitcnt lgkmcnt(4)
    buffer_store_dwordx4 v[64:67], v10, s[12:15], 0 offen sc1
    s_waitcnt lgkmcnt(3)
    buffer_store_dwordx4 v[68:71], v11, s[12:15], 0 offen sc1
    s_waitcnt lgkmcnt(2)
    buffer_store_dwordx4 v[72:75], v12, s[12:15], 0 offen sc1
    s_waitcnt lgkmcnt(1)
    buffer_store_dwordx4 v[76:79], v13, s[12:15], 0 offen sc1
    s_cselect_b32 exec_hi, -1, 0
    s_waitcnt lgkmcnt(0)
    buffer_store_dwordx4 v[80:83], v14, s[12:15], 0 offen sc1
    s_mov_b32 exec_hi, -1
    s_branch k2_fb
k2_ph1:
    v_add_u32 v4, 63360, v145
    v_add_u32 v5, 86976, v146
    s_mov_b32 s20, 0x0fff0fff
    s_mov_b32 s21, 0x0fff0fff
    s_mov_b64 exec, 1
    s_branch k2_hsp
k2_ph2:
    v_mov_b32 v4, v145
    v_add_u32 v5, 80640, v146
    s_mov_b64 exec, 1
    s_branch k2_hsp
k2_ph3:
    s_cmp_lg_u32 s37, 0
    s_cbranch_scc1 k2_sb
    s_waitcnt vmcnt(0)
    v_cmp_ne_u32 vcc, s87, v127
    s_cbranch_vccz k2_sb
    s_mov_b64 exec, 1
    v_mov_b32 v127, s87
    buffer_store_dword v127, off, s[8:11], 0 sc1
    s_mov_b64 exec, -1
k2_sb:
    v_add_u32 v4, 23040, v145
    v_add_u32 v5, 100176, v146
    s_waitcnt lgkmcnt(0)
    s_barrier
k2_hgo:
    s_mov_b64 exec, -1
    ds_read_b128 v[160:163], v4 offset:0
    ds_read_b128 v[164:167], v4 offset:128
    ds_read_b128 v[168:171], v4 offset:256
    ds_read_b128 v[172:175], v4 offset:384
    ds_read_b128 v[176:179], v4 offset:64
    ds_read_b128 v[180:183], v4 offset:192
    ds_read_b128 v[184:187], v4 offset:320
    ds_read_b128 v[188:191], v4 offset:448
    ds_read_b128 v[192:195], v4 offset:768
    ds_read_b128 v[196:199], v4 offset:640
    ds_read_b128 v[200:203], v4 offset:512
    ds_read_b128 v[204:207], v4 offset:1152
    v_add_u32 v149, 1, v149
    ds_read_b128 v[208:211], v4 offset:832
    s_waitcnt lgkmcnt(12)
    v_mfma_f32_16x16x32_bf16 v[128:131], v[24:27], v[160:163], 0
    ds_read_b128 v[212:215], v4 offset:704
    s_waitcnt lgkmcnt(12)
    v_mfma_f32_16x16x32_bf16 v[132:135], v[40:43], v[164:167], 0
    ds_read_b128 v[216:219], v4 offset:576
    s_waitcnt lgkmcnt(12)
    v_mfma_f32_16x16x32_bf16 v[136:139], v[40:43], v[168:171], 0
    ds_read_b128 v[220:223], v4 offset:1216
    s_waitcnt lgkmcnt(12)
    v_mfma_f32_16x16x32_bf16 v[140:143], v[40:43], v[172:175], 0
    ds_read_b128 v[224:227], v4 offset:1280
    s_waitcnt lgkmcnt(12)
    v_mfma_f32_16x16x32_bf16 v[128:131], v[28:31], v[176:179], v[128:131]
    ds_read_b128 v[228:231], v4 offset:1024
    s_waitcnt lgkmcnt(12)
    v_mfma_f32_16x16x32_bf16 v[132:135], v[44:47], v[180:183], v[132:135]
    ds_read_b128 v[232:235], v4 offset:896
    s_waitcnt lgkmcnt(12)
    v_mfma_f32_16x16x32_bf16 v[136:139], v[44:47], v[184:187], v[136:139]
    ds_read_b128 v[236:239], v4 offset:1344
    s_waitcnt lgkmcnt(12)
    v_mfma_f32_16x16x32_bf16 v[140:143], v[44:47], v[188:191], v[140:143]
    ds_read_b128 v[240:243], v4 offset:1088
    s_waitcnt lgkmcnt(12)
    v_mfma_f32_16x16x32_bf16 v[128:131], v[32:35], v[192:195], v[128:131]
    ds_read_b128 v[244:247], v4 offset:960
    s_waitcnt lgkmcnt(12)
    v_mfma_f32_16x16x32_bf16 v[132:135], v[48:51], v[196:199], v[132:135]
    s_waitcnt lgkmcnt(11)
    v_mfma_f32_16x16x32_bf16 v[136:139], v[48:51], v[200:203], v[136:139]
    s_waitcnt lgkmcnt(10)
    v_mfma_f32_16x16x32_bf16 v[140:143], v[48:51], v[204:207], v[140:143]
    s_waitcnt lgkmcnt(9)
    v_mfma_f32_16x16x32_bf16 v[128:131], v[36:39], v[208:211], v[128:131]
    s_waitcnt lgkmcnt(8)
    v_mfma_f32_16x16x32_bf16 v[132:135], v[52:55], v[212:215], v[132:135]
    s_waitcnt lgkmcnt(7)
    v_mfma_f32_16x16x32_bf16 v[136:139], v[52:55], v[216:219], v[136:139]
    s_waitcnt lgkmcnt(6)
    v_mfma_f32_16x16x32_bf16 v[140:143], v[52:55], v[220:223], v[140:143]
    s_cmp_lg_u32 s25, 0
    s_cbranch_scc1 k2_q0
    v_add_f32_dpp v128, v128, v128 quad_perm:[1,0,3,2] row_mask:0xf bank_mask:0x8
    v_add_f32_dpp v129, v129, v129 quad_perm:[1,0,3,2] row_mask:0xf bank_mask:0x8
    v_add_f32_dpp v130, v130, v130 quad_perm:[1,0,3,2] row_mask:0xf bank_mask:0x8
    v_add_f32_dpp v131, v131, v131 quad_perm:[1,0,3,2] row_mask:0xf bank_mask:0x8
    v_add_f32_dpp v128, v128, v128 quad_perm:[2,3,0,1] row_mask:0xf bank_mask:0x8
    v_add_f32_dpp v129, v129, v129 quad_perm:[2,3,0,1] row_mask:0xf bank_mask:0x8
    v_add_f32_dpp v130, v130, v130 quad_perm:[2,3,0,1] row_mask:0xf bank_mask:0x8
    v_add_f32_dpp v131, v131, v131 quad_perm:[2,3,0,1] row_mask:0xf bank_mask:0x8
k2_q0:
    v_mul_f32 v16, s33, v128
    v_mul_f32 v17, s33, v129
    v_mul_f32 v18, s33, v130
    v_mul_f32 v19, s33, v131
    s_waitcnt lgkmcnt(5)
    v_mfma_f32_16x16x32_bf16 v[132:135], v[56:59], v[224:227], v[132:135]
    v_exp_f32 v16, v16
    v_exp_f32 v17, v17
    v_exp_f32 v18, v18
    v_exp_f32 v19, v19
    s_waitcnt lgkmcnt(4)
    v_mfma_f32_16x16x32_bf16 v[136:139], v[56:59], v[228:231], v[136:139]
    v_cvt_pk_bf16_f32 v128, v128, v129
    v_cvt_pk_bf16_f32 v129, v130, v131
    v_add_f32 v16, 1.0, v16
    v_add_f32 v17, 1.0, v17
    v_add_f32 v18, 1.0, v18
    v_add_f32 v19, 1.0, v19
    s_waitcnt lgkmcnt(3)
    v_mfma_f32_16x16x32_bf16 v[140:143], v[56:59], v[232:235], v[140:143]
    v_rcp_f32 v16, v16
    v_rcp_f32 v17, v17
    v_rcp_f32 v18, v18
    v_rcp_f32 v19, v19
    s_waitcnt lgkmcnt(2)
    v_mfma_f32_16x16x32_bf16 v[132:135], v[60:63], v[236:239], v[132:135]
    s_waitcnt lgkmcnt(1)
    v_mfma_f32_16x16x32_bf16 v[136:139], v[60:63], v[240:243], v[136:139]
    s_waitcnt lgkmcnt(0)
    v_mfma_f32_16x16x32_bf16 v[140:143], v[60:63], v[244:247], v[140:143]
    s_cmp_lg_u32 s25, 0
    s_cbranch_scc1 k2_q1
    s_nop 1
    v_add_f32_dpp v132, v132, v132 quad_perm:[1,0,3,2] row_mask:0xf bank_mask:0x8
    v_add_f32_dpp v133, v133, v133 quad_perm:[1,0,3,2] row_mask:0xf bank_mask:0x8
    v_add_f32_dpp v134, v134, v134 quad_perm:[1,0,3,2] row_mask:0xf bank_mask:0x8
    v_add_f32_dpp v135, v135, v135 quad_perm:[1,0,3,2] row_mask:0xf bank_mask:0x8
    v_add_f32_dpp v136, v136, v136 quad_perm:[1,0,3,2] row_mask:0xf bank_mask:0x8
    v_add_f32_dpp v137, v137, v137 quad_perm:[1,0,3,2] row_mask:0xf bank_mask:0x8
    v_add_f32_dpp v138, v138, v138 quad_perm:[1,0,3,2] row_mask:0xf bank_mask:0x8
    v_add_f32_dpp v139, v139, v139 quad_perm:[1,0,3,2] row_mask:0xf bank_mask:0x8
    v_add_f32_dpp v140, v140, v140 quad_perm:[1,0,3,2] row_mask:0xf bank_mask:0x8
    v_add_f32_dpp v141, v141, v141 quad_perm:[1,0,3,2] row_mask:0xf bank_mask:0x8
    v_add_f32_dpp v142, v142, v142 quad_perm:[1,0,3,2] row_mask:0xf bank_mask:0x8
    v_add_f32_dpp v143, v143, v143 quad_perm:[1,0,3,2] row_mask:0xf bank_mask:0x8
    v_add_f32_dpp v132, v132, v132 quad_perm:[2,3,0,1] row_mask:0xf bank_mask:0x8
    v_add_f32_dpp v133, v133, v133 quad_perm:[2,3,0,1] row_mask:0xf bank_mask:0x8
    v_add_f32_dpp v134, v134, v134 quad_perm:[2,3,0,1] row_mask:0xf bank_mask:0x8
    v_add_f32_dpp v135, v135, v135 quad_perm:[2,3,0,1] row_mask:0xf bank_mask:0x8
    v_add_f32_dpp v136, v136, v136 quad_perm:[2,3,0,1] row_mask:0xf bank_mask:0x8
    v_add_f32_dpp v137, v137, v137 quad_perm:[2,3,0,1] row_mask:0xf bank_mask:0x8
    v_add_f32_dpp v138, v138, v138 quad_perm:[2,3,0,1] row_mask:0xf bank_mask:0x8
    v_add_f32_dpp v139, v139, v139 quad_perm:[2,3,0,1] row_mask:0xf bank_mask:0x8
    v_add_f32_dpp v140, v140, v140 quad_perm:[2,3,0,1] row_mask:0xf bank_mask:0x8
    v_add_f32_dpp v141, v141, v141 quad_perm:[2,3,0,1] row_mask:0xf bank_mask:0x8
    v_add_f32_dpp v142, v142, v142 quad_perm:[2,3,0,1] row_mask:0xf bank_mask:0x8
    v_add_f32_dpp v143, v143, v143 quad_perm:[2,3,0,1] row_mask:0xf bank_mask:0x8
k2_q1:
    s_mov_b64 exec, s[20:21]
    ds_write_b64 v5, v[128:129] offset:0
    v_pk_mul_f32 v[132:133], v[132:133], v[16:17]
    v_pk_mul_f32 v[134:135], v[134:135], v[18:19]
    v_cvt_pk_bf16_f32 v132, v132, v133
    v_cvt_pk_bf16_f32 v133, v134, v135
    ds_write_b64 v5, v[132:133] offset:128
    v_pk_mul_f32 v[136:137], v[136:137], v[16:17]
    v_pk_mul_f32 v[138:139], v[138:139], v[18:19]
    v_cvt_pk_bf16_f32 v136, v136, v137
    v_cvt_pk_bf16_f32 v137, v138, v139
    ds_write_b64 v5, v[136:137] offset:256
    v_pk_mul_f32 v[140:141], v[140:141], v[16:17]
    v_pk_mul_f32 v[142:143], v[142:143], v[18:19]
    v_cvt_pk_bf16_f32 v140, v140, v141
    v_cvt_pk_bf16_f32 v141, v142, v143
    ds_write_b64 v5, v[140:141] offset:384
    s_mov_b64 exec, -1
    s_cmp_eq_u32 s25, 3
    s_cbranch_scc1 k2_fb
    s_add_u32 s25, s25, 1
    s_cmp_eq_u32 s25, 1
    s_cbranch_scc1 k2_ph1
    s_cmp_eq_u32 s25, 2
    s_cbranch_scc1 k2_ph2
    s_branch k2_ph3
k2_fb:
    v_add_u32 v151, v151, v147
    s_cmp_ge_u32 s16, 6
    s_waitcnt lgkmcnt(0)
    s_barrier
    s_cbranch_scc1 k2_out
    ds_read_b128 v[88:91], v150
    s_waitcnt lgkmcnt(0)
    buffer_store_dwordx4 v[88:91], v151, s[12:15], 0 offen sc1
k2_out:
k2_end:
    s_endpgm
.section .rodata,"a"
.p2align 6
.amdhsa_kernel gather_scatter__tensor_product_equiv_equiformer__graph_kernel
  .amdhsa_next_free_vgpr 256
  .amdhsa_next_free_sgpr 102
  .amdhsa_accum_offset 256
  .amdhsa_group_segment_fixed_size 0
  .amdhsa_kernarg_size 96
  .amdhsa_user_sgpr_count 2
  .amdhsa_user_sgpr_kernarg_segment_ptr 1
  .amdhsa_system_sgpr_workgroup_id_x 1
.end_amdhsa_kernel
```
